```python
import torch

def _softmax(x, axis=-1):
    return torch.softmax(x, dim=axis)

def _gelu(x):
    return torch.nn.functional.gelu(x, approximate='tanh')

def _silu(x):
    return torch.nn.functional.silu(x)

def _sigmoid(x):
    return torch.sigmoid(x)

def _layernorm(x, axis=-1, eps=1e-05):
    m = x.mean(dim=axis, keepdim=True)
    v = x.var(dim=axis, keepdim=True, unbiased=False)
    return (x - m) / torch.sqrt(v + eps)

def _scatter_add(tgt, idx, src, axis=0):
    return tgt.clone().index_add_(axis, idx, src)

def _segment_sum(src, seg, n):
    out = torch.zeros((n,) + src.shape[1:], dtype=src.dtype)
    return out.index_add_(0, seg, src)

def _pad(x, pw):
    flat = tuple((v for pair in reversed(pw) for v in pair))
    return torch.nn.functional.pad(x, flat)
kernel_name = 'adaLN_cond__ssm_conv_h3__glu_gated_bilinear__prompt'

def setup_inputs():

    _w = lambda a: (lambda t: t.to(torch.bfloat16) if t.is_floating_point() else t)(torch.as_tensor(a))

    def _A_setup():
        B, S, D = (1, 2048, 448)
        ks = 4
        return {'q': _w((lambda *s: torch.randn(*s, dtype=torch.bfloat16) * 0.05)(B, S, D)), 'k': _w((lambda *s: torch.randn(*s, dtype=torch.bfloat16) * 0.8)(B, S, D)), 'v': _w((lambda *s: torch.randn(*s, dtype=torch.bfloat16) * 0.8)(B, S, D)), 'shift_k': _w((lambda *s: torch.randn(*s, dtype=torch.bfloat16) * 0.8)(D, ks) * 0.5), 'ssm_k': _w((lambda *s: torch.randn(*s, dtype=torch.bfloat16) * 0.8)(D, S) * (1.0 / S ** 0.5)), 'ssm_D': _w((lambda *s: torch.randn(*s, dtype=torch.bfloat16) * 0.8)(D))}
    _A_in = _A_setup()

    def _B_setup():
        B, S, D, F = (1, 2048, 448, 1792)
        return {'x': _w((lambda *s: torch.randn(*s, dtype=torch.bfloat16) * 0.05)(B, S, D)), 'w_gate': _w((lambda *s: torch.randn(*s, dtype=torch.bfloat16) * 0.8)(D, F) * D ** (-0.5)), 'w_up': _w((lambda *s: torch.randn(*s, dtype=torch.bfloat16) * 0.8)(D, F) * D ** (-0.5)), 'w_down': _w((lambda *s: torch.randn(*s, dtype=torch.bfloat16) * 0.8)(F, D) * F ** (-0.5))}
    _B_in = _B_setup()
    return {'A_q': _A_in['q'], 'A_k': _A_in['k'], 'A_v': _A_in['v'], 'A_shift_k': _A_in['shift_k'], 'A_ssm_k': _A_in['ssm_k'], 'A_ssm_D': _A_in['ssm_D'], 'B_x': _B_in['x'], 'B_w_gate': _B_in['w_gate'], 'B_w_up': _B_in['w_up'], 'B_w_down': _B_in['w_down'], 'c': _w((lambda *s: torch.randn(*s, dtype=torch.bfloat16) * 0.2)(1, 448) * 8.0), 'w_mod': _w((lambda *s: torch.randn(*s, dtype=torch.bfloat16) * 0.2)(448, 6 * 448) * 448 ** (-0.5) * 8.0)}

def reference(A_q, A_k, A_v, A_shift_k, A_ssm_k, A_ssm_D, B_x, B_w_gate, B_w_up, B_w_down, c, w_mod):

    def _A_ref(q, k, v, shift_k, ssm_k, ssm_D):
        B, S, D = q.shape
        ks = shift_k.shape[-1]
        k_pad = _pad(k, ((0, 0), (ks - 1, 0), (0, 0)))
        k_shift = torch.zeros_like(k)
        for t in range(ks):
            k_shift = k_shift + k_pad[:, t:t + S, :] * shift_k[:, ks - 1 - t][None, None, :]
        kv = k_shift * v
        L = 2 * S
        kv_pad = _pad(kv, ((0, 0), (0, S), (0, 0)))
        kf_pad = _pad(ssm_k, ((0, 0), (0, S)))
        kv_f = (lambda x, axes=(-2, -1): torch.fft.rfft2(x.float(), dim=axes))(kv_pad[:, None, :, :], axes=(1, 2))
        kf_f = (lambda x, axes=(-2, -1): torch.fft.rfft2(x.float(), dim=axes))(kf_pad[:, None, :], axes=(1, 2))
        kf_f = (lambda x, *d: x.permute(*d))(kf_f, 1, 2, 0)
        y_f = kv_f * kf_f[None, :, :, :]
        y = (lambda x, s, axes=(-2, -1): torch.fft.irfft2(x, s=s, dim=axes).to(torch.bfloat16))(y_f, (1, L), axes=(1, 2))[:, 0, :S, :]
        y = y + kv * ssm_D[None, None, :]
        return q * y

    def _B_ref(x, w_gate, w_up, w_down):
        g = torch.einsum('bsd,df->bsf', x, w_gate)
        u = torch.einsum('bsd,df->bsf', x, w_up)
        h = g * u
        return torch.einsum('bsf,fd->bsd', h, w_down)
    x = A_q
    mod = (_silu(c) @ w_mod).reshape(c.shape[0], 6, 1, -1)
    sa, ca, ga, sb, cb, gb = (mod[:, 0].clone(), mod[:, 1].clone(), mod[:, 2].clone(), mod[:, 3].clone(), mod[:, 4].clone(), mod[:, 5].clone())
    h = _layernorm(x, axis=-1) * (1 + ca) + sa
    x = x + ga * _A_ref(h, A_k, A_v, A_shift_k, A_ssm_k, A_ssm_D)
    h = _layernorm(x, axis=-1) * (1 + cb) + sb
    x = x + gb * _B_ref(h, B_w_gate, B_w_up, B_w_down)
    return x
```

```asm
; @launch grid=(256,1,1) block=(256,1,1) lds=163840
.amdgcn_target "amdgcn-amd-amdhsa--gfx950"
.text
.globl adaLN_cond__ssm_conv_h3__glu_gated_bilinear__prompt_kernel
.p2align 8
.type adaLN_cond__ssm_conv_h3__glu_gated_bilinear__prompt_kernel,@function
adaLN_cond__ssm_conv_h3__glu_gated_bilinear__prompt_kernel:
L_begin:
    s_cmp_ge_u32 s2, 256
    s_cbranch_scc1 L_exit
    s_lshr_b32 s59, s2, 3
    s_cmp_ge_u32 s59, 28
    s_cbranch_scc1 L_mod
    s_load_dwordx2 s[4:5], s[0:1], 8
    s_load_dwordx2 s[8:9], s[0:1], 16
    s_load_dwordx2 s[12:13], s[0:1], 24
    s_load_dwordx2 s[20:21], s[0:1], 32
    s_load_dwordx2 s[24:25], s[0:1], 112
    s_load_dwordx2 s[48:49], s[0:1], 88
    s_load_dwordx2 s[44:45], s[0:1], 40
    s_getpc_b64 s[52:53]
L_pc_1:
    s_sub_u32 s52, s52, L_pc_1-L_begin
    s_subb_u32 s53, s53, 0
    s_mov_b32 s54, L_code_end-L_begin
    s_mov_b32 s55, 0x20000
    s_and_b32 s58, s2, 7
    s_lshl_b32 s64, s59, 7
    v_lshlrev_b32_e64 v5, 12, v0
    buffer_load_dword a248, v5, s[52:55], s64 offen
    v_lshrrev_b32 v2, 6, v0
    v_and_b32 v1, 63, v0
    s_mov_b32 s70, 0
    s_mov_b32 s3, 1
    s_nop 0
    v_readfirstlane_b32 s60, v2
    s_mov_b32 s71, 0xffff0000
    s_mov_b32 s6, 1835008
    s_mov_b32 s7, 0x20000
    s_mov_b32 s10, 1835008
    s_mov_b32 s11, 0x20000
    s_mov_b32 s14, 3584
    s_mov_b32 s15, 0x20000
    s_mul_i32 s56, s58, 28
    s_add_u32 s56, s56, s59
    s_lshr_b32 s46, s56, 5
    s_and_b32 s47, s56, 31
    s_lshl_b32 s64, s47, 2
    s_add_u32 s64, s64, s60
    s_mul_i32 s64, s64, 14336
    s_lshl_b32 s65, s46, 7
    s_add_u32 s64, s64, s65
    v_lshrrev_b32 v124, 5, v1
    v_and_b32 v125, 31, v1
    v_mul_u32_u24 v233, 7168, v124
    v_lshl_add_u32 v233, v125, 2, v233
    v_add_u32_e64 v233, s64, v233
    v_add_u32 v234, 3584, v233
    v_subrev_u32 v235, 2688, v233
    s_lshl_b32 s65, s46, 9
    v_lshlrev_b32 v126, 4, v125
    s_lshl_b32 s66, s56, 2
    s_lshl_b32 s67, s56, 1
    s_lshr_b32 s68, s60, 1
    s_add_u32 s67, s67, s68
    s_lshl_b32 s67, s67, 12
    s_waitcnt lgkmcnt(0)
    buffer_load_dwordx4 v[148:151], v126, s[12:15], s65 offen
    buffer_load_dword v128, v235, s[4:7], 0 offen offset:0
    buffer_load_dword v129, v235, s[4:7], 0 offen offset:896
    buffer_load_dword v130, v235, s[4:7], 0 offen offset:1792
    buffer_load_dword v131, v233, s[4:7], 0 offen offset:0
    buffer_load_dword v139, v233, s[8:11], 0 offen offset:0
    s_load_dword s63, s[24:25], 0
    buffer_load_dword v132, v233, s[4:7], 0 offen offset:896
    buffer_load_dword v140, v233, s[8:11], 0 offen offset:896
    s_load_dword s62, s[44:45], s66
    buffer_load_dword v133, v233, s[4:7], 0 offen offset:1792
    buffer_load_dword v141, v233, s[8:11], 0 offen offset:1792
    s_load_dword s57, s[20:21], s67
    buffer_load_dword v134, v233, s[4:7], 0 offen offset:2688
    buffer_load_dword v142, v233, s[8:11], 0 offen offset:2688
    s_load_dwordx2 s[28:29], s[0:1], 56
    buffer_load_dword v135, v234, s[4:7], 0 offen offset:0
    buffer_load_dword v143, v234, s[8:11], 0 offen offset:0
    s_load_dwordx2 s[32:33], s[0:1], 64
    buffer_load_dword v136, v234, s[4:7], 0 offen offset:896
    buffer_load_dword v144, v234, s[8:11], 0 offen offset:896
    s_load_dwordx2 s[36:37], s[0:1], 72
    buffer_load_dword v137, v234, s[4:7], 0 offen offset:1792
    buffer_load_dword v145, v234, s[8:11], 0 offen offset:1792
    s_load_dwordx2 s[40:41], s[0:1], 96
    buffer_load_dword v138, v234, s[4:7], 0 offen offset:2688
    buffer_load_dword v146, v234, s[8:11], 0 offen offset:2688
    s_load_dwordx2 s[16:17], s[0:1], 0
    s_mov_b32 s22, 1835008
    s_mov_b32 s23, 0x20000
    s_mov_b32 s50, 2408448
    s_mov_b32 s51, 0x20000
    s_mov_b32 s18, 1835008
    s_mov_b32 s19, 0x20000
    s_mov_b32 s26, 20152320
    s_mov_b32 s27, 0x20000
    s_mov_b32 s30, 1605632
    s_mov_b32 s31, 0x20000
    s_mov_b32 s34, 1606656
    s_mov_b32 s35, 0x20000
    s_mov_b32 s38, 1605632
    s_mov_b32 s39, 0x20000
    s_mov_b32 s42, 1835008
    s_mov_b32 s43, 0x20000
    s_lshl_b32 s64, s60, 1
    v_add_u32 v126, s64, v124
    v_xor_b32 v126, v126, v125
    v_and_b32 v126, 7, v126
    v_lshlrev_b32_e64 v126, 4, v126
    v_lshl_add_u32 v228, v125, 8, v126
    v_and_b32_e64 v126, 3, v1
    v_bfe_u32 v127, v1, 2, 1
    v_lshl_add_u32 v126, v126, 1, v127
    v_lshrrev_b32 v127, 4, v1
    v_xor_b32 v126, v126, v127
    v_lshlrev_b32 v126, 4, v126
    v_lshrrev_b32 v127, 3, v1
    v_lshl_add_u32 v126, v127, 7, v126
    s_lshl_b32 s65, s60, 11
    v_add_u32 v224, s65, v126
    v_xor_b32 v225, 64, v224
    s_lshl_b32 s64, s46, 2
    s_add_u32 s64, s64, s60
    s_mul_i32 s64, s64, 67584
    s_lshl_b32 s65, s47, 7
    s_add_u32 s64, s64, s65
    s_add_u32 s64, s64, 4718592
    v_mul_u32_u24 v229, 4224, v127
    v_and_b32 v127, 7, v1
    v_lshl_add_u32 v229, v127, 4, v229
    v_add_u32 v229, s64, v229
    s_lshr_b32 s64, s56, 4
    s_lshl_b32 s64, s64, 2
    s_add_u32 s64, s64, s60
    s_mul_i32 s64, s64, 256
    s_add_u32 s52, s64, 20070400
    s_lshl_b32 s64, s46, 1
    s_and_b32 s65, s60, 1
    s_add_u32 s64, s64, s65
    s_lshl_b32 s64, s64, 2
    s_and_b32 s65, s56, 3
    s_add_u32 s64, s64, s65
    s_mul_i32 s64, s64, 256
    s_add_u32 s53, s64, 20070400
    s_and_b32 s64, s56, 15
    s_cmp_eq_u32 s64, 0
    s_cselect_b32 s54, s52, 1073741824
    v_lshlrev_b32 v238, 4, v127
    v_lshrrev_b32 v126, 3, v1
    v_add_u32 v127, 3, v126
    v_lshrrev_b32_e64 v127, 3, v127
    v_mul_u32_u24 v237, 16384, v126
    v_add_u32_e64 v237, v237, v238
    v_lshl_add_u32 v237, v127, 25, v237
    v_lshl_add_u32 v238, v126, 25, v238
    s_mul_i32 s45, s68, 8448
    s_and_b32 s65, s60, 1
    s_lshl_b32 s65, s65, 11
    s_add_u32 s72, s45, s65
    s_add_u32 s73, s67, s65
    v_lshlrev_b32_e64 v14, 4, v1
    s_add_u32 m0, s72, 146976
    s_add_u32 s73, s73, 0
    buffer_load_dwordx4 v14, s[20:23], s73 offen lds
    buffer_load_dwordx4 v14, s[20:23], s73 offen offset:1024 lds
    s_add_u32 m0, s72, 151200
    s_add_u32 s73, s73, 4
    buffer_load_dwordx4 v14, s[20:23], s73 offen lds
    buffer_load_dwordx4 v14, s[20:23], s73 offen offset:1024 lds
    v_mov_b32 v124, 1073741824
    v_lshrrev_b32 v125, 3, v1
    v_mul_u32_u24 v125, 5376, v125
    v_bfe_u32 v126, v1, 1, 2
    v_lshl_add_u32 v126, v126, 3, s58
    v_lshl_add_u32 v125, v126, 8, v125
    v_and_b32_e64 v127, 1, v1
    v_lshl_add_u32 v125, v127, 7, v125
    v_and_b32 v127, 32, v1
    v_add_u32 v126, v126, v127
    v_cmp_gt_u32 vcc, 21, v126
    s_lshl_b32 s64, s59, 2
    s_add_u32 s64, s64, s60
    s_mul_i32 s74, s64, 21504
    v_cndmask_b32 v239, v124, v125, vcc
    buffer_load_dword a247, v239, s[48:51], s74 offen
    v_lshlrev_b32 v126, 7, v1
    v_cmp_gt_u32 vcc, 16, v1
    s_add_u32 s69, s66, s60
    s_mul_i32 s81, s69, 1792
    v_cndmask_b32 v72, v124, v126, vcc
    s_and_b32 s64, s58, 3
    s_mul_i32 s64, s64, 28
    s_add_u32 s65, s64, s59
    s_lshr_b32 s80, s65, 3
    s_and_b32 s79, s65, 7
    s_lshr_b32 s65, s58, 2
    s_lshl_b32 s65, s65, 3
    s_add_u32 s79, s79, s65
    s_add_u32 s65, s64, 27
    s_lshr_b32 s65, s65, 3
    s_lshr_b32 s64, s64, 3
    s_sub_u32 s65, s65, s64
    s_lshl_b32 s65, s65, 1
    s_add_u32 s65, s65, 2
    v_and_b32 v126, 47, v1
    v_cmp_gt_u32 vcc, s65, v126
    v_lshrrev_b32_e64 v125, 4, v1
    v_mul_u32_u24 v125, 3584, v125
    v_lshl_add_u32 v125, v126, 7, v125
    v_cndmask_b32 v73, v124, v125, vcc
    s_lshl_b32 s68, s64, 8
    s_lshl_b32 s64, s59, 2
    s_add_u32 s64, s64, s60
    s_lshl_b32 s64, s64, 2
    s_lshr_b32 s65, s58, 2
    s_mul_i32 s65, s65, 4
    s_and_b32 s65, s65, 3
    s_add_u32 s64, s64, s65
    s_mul_i32 s64, s64, 3584
    s_add_u32 s68, s68, s64
    s_lshl_b32 s64, s60, 3
    s_add_u32 s64, s64, s58
    s_mul_i32 s75, s64, 57344
    s_lshl_b32 s64, s59, 11
    s_add_u32 s75, s75, s64
    s_mul_i32 s47, s69, 256
    s_add_u32 s47, s47, 20004864
    s_cmp_lt_u32 s69, 256
    s_cselect_b32 s47, s47, 1073741824
    s_lshl_b32 s64, s80, 8
    s_mul_i32 s65, s60, 14336
    s_add_u32 s64, s64, s65
    v_lshrrev_b32 v124, 4, v1
    v_bfe_u32 v125, v1, 2, 2
    v_xor_b32_e64 v126, v125, v124
    v_mul_u32_u24 v65, 3584, v124
    v_lshl_add_u32 v65, v126, 6, v65
    v_and_b32_e64 v126, 3, v1
    v_lshl_add_u32 v65, v126, 4, v65
    v_add_u32 v65, s64, v65
    v_lshlrev_b32 v66, 4, v126
    v_lshl_add_u32 v66, v124, 12, v66
    v_lshl_add_u32 v66, v125, 8, v66
    v_xor_b32_e64 v125, s60, v125
    v_lshl_add_u32 v66, v125, 6, v66
    v_add_u32 v66, 32768, v66
    v_add_u32 v67, 65536, v66
    s_lshl_b32 s44, s60, 11
    s_add_u32 s44, s44, 32768
    s_lshr_b32 s64, s60, 1
    s_and_b32 s65, s60, 1
    s_mul_i32 s66, s64, 8448
    s_lshl_b32 s67, s65, 8
    s_add_u32 s66, s66, s67
    s_add_u32 s66, s66, 147136
    v_bfe_u32 v124, v1, 1, 3
    v_lshlrev_b32 v125, 2, v124
    v_and_b32_e64 v124, 1, v124
    v_mul_u32_u24 v124, 4220, v124
    v_add_u32 v124, v124, v125
    v_lshrrev_b32 v125, 4, v1
    v_lshlrev_b32 v125, 6, v125
    v_sub_u32 v124, v124, v125
    v_add_u32 v60, s66, v124
    v_and_b32 v124, 1, v1
    v_cmp_eq_u32_e64 vcc, 1, v124
    v_mov_b32 v61, 0x03020504
    v_mov_b32 v125, 0x05040706
    v_cndmask_b32 v61, v61, v125, vcc
    s_lshl_b32 s66, s56, 1
    s_lshr_b32 s67, s60, 1
    s_add_u32 s66, s66, s67
    s_mul_i32 s66, s66, 4224
    s_and_b32 s64, s60, 1
    s_lshl_b32 s65, s64, 11
    s_add_u32 s66, s66, s65
    s_add_u32 s46, s66, 4718592
    s_mul_i32 s67, s67, 4736
    s_lshl_b32 s64, s64, 10
    s_add_u32 s67, s67, s64
    s_add_u32 s55, s67, 256
    v_lshrrev_b32 v124, 2, v1
    v_and_b32 v125, 3, v1
    v_lshlrev_b32 v125, 4, v125
    v_lshl_add_u32 v62, v124, 7, v125
    s_lshr_b32 s64, s60, 1
    s_and_b32 s65, s60, 1
    s_mul_i32 s64, s64, 4736
    s_lshl_b32 s65, s65, 7
    s_sub_u32 s64, s64, s65
    s_add_u32 s64, s64, 144
    v_and_b32 v124, 15, v1
    v_lshrrev_b32 v125, 4, v1
    v_lshlrev_b32_e64 v68, 4, v124
    v_lshl_add_u32 v68, v125, 5, v68
    v_add_u32_e64 v68, s64, v68
    s_mul_i32 s64, s60, 2560
    v_mul_u32_u24 v69, 320, v125
    v_lshl_add_u32 v69, v124, 4, v69
    v_add_u32 v69, s64, v69
    v_lshrrev_b32 v124, 7, v0
    v_mul_u32_u24 v70, 1280, v124
    v_bfe_u32 v124, v0, 1, 2
    v_mul_u32_u24 v124, 320, v124
    v_add_u32_e64 v70, v70, v124
    v_bfe_u32 v124, v0, 3, 4
    v_lshl_add_u32 v70, v124, 4, v70
    v_and_b32_e64 v124, 1, v0
    v_lshl_add_u32 v70, v124, 3, v70
    v_bfe_u32 v124, v0, 2, 1
    v_mul_u32_u24 v64, 2368, v124
    v_lshrrev_b32_e64 v124, 3, v0
    v_lshl_add_u32 v64, v124, 4, v64
    v_and_b32_e64 v124, 3, v0
    v_lshl_add_u32 v64, v124, 2, v64
    v_lshlrev_b32_e64 v71, 4, v0
    s_mul_i32 s64, s56, 8320
    s_add_u32 s64, s64, 8454144
    v_add_u32 v71, s64, v71
    v_mov_b32 v104, 0
    v_mov_b32 v105, 0
    v_mov_b32 v106, 0
    v_mov_b32 v107, 0
    v_lshrrev_b32 v124, 4, v1
    v_and_b32_e64 v125, 15, v1
    v_mul_u32_u24 v126, 2368, v124
    v_lshl_add_u32 v126, v125, 4, v126
    ds_write_b128 v126, v[104:107] offset:0
    v_bfe_u32 v124, v1, 1, 1
    v_mul_u32_u24 v126, 4224, v124
    v_and_b32_e64 v125, 1, v1
    v_lshl_add_u32 v126, v125, 4, v126
    v_add_u32_e64 v126, s45, v126
    v_add_u32 v126, 146944, v126
    v_and_b32 v124, v124, v125
    s_waitcnt vmcnt(24)
    v_and_b32 v152, 0xffff, v148
    v_lshlrev_b32 v156, 16, v150
    v_lshrrev_b32 v153, 16, v148
    v_and_b32_e64 v157, s71, v150
    v_and_b32 v154, 0xffff, v149
    v_lshlrev_b32 v158, 16, v151
    v_lshrrev_b32 v155, 16, v149
    v_and_b32 v159, s71, v151
    s_waitcnt vmcnt(23)
    v_dot2_f32_bf16 v160, v128, v155, 0
    v_dot2_f32_bf16 v161, v128, v159, 0
    s_waitcnt vmcnt(22)
    v_dot2_f32_bf16 v162, v129, v155, 0
    v_dot2_f32_bf16 v163, v129, v159, 0
    v_dot2_f32_bf16 v160, v129, v154, v160
    v_dot2_f32_bf16 v161, v129, v158, v161
    s_waitcnt vmcnt(21)
    v_dot2_f32_bf16 v162, v130, v154, v162
    v_dot2_f32_bf16 v163, v130, v158, v163
    v_dot2_f32_bf16 v160, v130, v153, v160
    v_dot2_f32_bf16 v161, v130, v157, v161
    s_waitcnt vmcnt(20)
    v_dot2_f32_bf16 v162, v131, v153, v162
    v_dot2_f32_bf16 v163, v131, v157, v163
    v_dot2_f32_bf16 v160, v131, v152, v160
    v_dot2_f32_bf16 v161, v131, v156, v161
    s_waitcnt vmcnt(18)
    v_dot2_f32_bf16 v162, v132, v152, v162
    v_dot2_f32_bf16 v163, v132, v156, v163
    v_lshlrev_b32 v176, 16, v139
    v_and_b32 v177, s71, v139
    s_waitcnt vmcnt(17)
    v_lshlrev_b32 v178, 16, v140
    v_and_b32_e64 v179, s71, v140
    v_pk_mul_f32 v[160:161], v[160:161], v[176:177]
    v_pk_mul_f32 v[162:163], v[162:163], v[178:179]
    v_cvt_pk_bf16_f32 v192, v160, v162
    v_cvt_pk_bf16_f32 v196, v161, v163
    s_waitcnt lgkmcnt(0)
    v_mul_lo_u32 v107, s57, v124
    s_sub_u32 s32, s32, 1024
    s_subb_u32 s33, s33, 0
    ds_write_b128 v126, v[104:107]
    s_mul_i32 s61, s63, 0x9E3779B1
    s_lshr_b32 s61, s61, 4
    s_add_u32 s61, s61, s63
    s_add_u32 s61, s61, 0x3C6EF372
    s_bitset0_b32 s61, 31
    v_mov_b32 v2, s61
    v_mov_b32_e64 v108, v2
    buffer_store_dwordx4 v[108:111], v237, s[24:27], s54 offen sc0 sc1
    buffer_load_dword a251, v72, s[16:19], s75 offen
    v_dot2_f32_bf16 v164, v130, v155, 0
    v_dot2_f32_bf16 v165, v130, v159, 0
    v_dot2_f32_bf16 v166, v131, v155, 0
    v_dot2_f32_bf16 v167, v131, v159, 0
    v_dot2_f32_bf16 v164, v131, v154, v164
    v_dot2_f32_bf16 v165, v131, v158, v165
    v_dot2_f32_bf16 v166, v132, v154, v166
    v_dot2_f32_bf16 v167, v132, v158, v167
    v_dot2_f32_bf16 v164, v132, v153, v164
    v_dot2_f32_bf16 v165, v132, v157, v165
    s_waitcnt vmcnt(18)
    v_dot2_f32_bf16 v166, v133, v153, v166
    v_dot2_f32_bf16 v167, v133, v157, v167
    v_dot2_f32_bf16 v164, v133, v152, v164
    v_dot2_f32_bf16 v165, v133, v156, v165
    s_waitcnt vmcnt(16)
    v_dot2_f32_bf16 v166, v134, v152, v166
    v_dot2_f32_bf16 v167, v134, v156, v167
    v_lshlrev_b32 v180, 16, v141
    v_and_b32 v181, s71, v141
    s_waitcnt vmcnt(15)
    v_lshlrev_b32 v182, 16, v142
    v_and_b32_e64 v183, s71, v142
    v_pk_mul_f32 v[164:165], v[164:165], v[180:181]
    v_pk_mul_f32 v[166:167], v[166:167], v[182:183]
    v_cvt_pk_bf16_f32 v193, v164, v166
    v_cvt_pk_bf16_f32 v197, v165, v167
    v_dot2_f32_bf16 v168, v132, v155, 0
    v_dot2_f32_bf16 v169, v132, v159, 0
    v_dot2_f32_bf16 v170, v133, v155, 0
    v_dot2_f32_bf16 v171, v133, v159, 0
    v_dot2_f32_bf16 v168, v133, v154, v168
    v_dot2_f32_bf16 v169, v133, v158, v169
    v_dot2_f32_bf16 v170, v134, v154, v170
    v_dot2_f32_bf16 v171, v134, v158, v171
    v_dot2_f32_bf16 v168, v134, v153, v168
    v_dot2_f32_bf16 v169, v134, v157, v169
    s_waitcnt vmcnt(14)
    v_dot2_f32_bf16 v170, v135, v153, v170
    v_dot2_f32_bf16 v171, v135, v157, v171
    v_dot2_f32_bf16 v168, v135, v152, v168
    v_dot2_f32_bf16 v169, v135, v156, v169
    s_waitcnt vmcnt(12)
    v_dot2_f32_bf16 v170, v136, v152, v170
    v_dot2_f32_bf16 v171, v136, v156, v171
    v_lshlrev_b32 v184, 16, v143
    v_and_b32 v185, s71, v143
    s_waitcnt vmcnt(11)
    v_lshlrev_b32 v186, 16, v144
    v_and_b32_e64 v187, s71, v144
    v_pk_mul_f32 v[168:169], v[168:169], v[184:185]
    v_pk_mul_f32 v[170:171], v[170:171], v[186:187]
    v_cvt_pk_bf16_f32 v194, v168, v170
    v_cvt_pk_bf16_f32 v198, v169, v171
    v_dot2_f32_bf16 v172, v134, v155, 0
    v_dot2_f32_bf16 v173, v134, v159, 0
    v_dot2_f32_bf16 v174, v135, v155, 0
    v_dot2_f32_bf16 v175, v135, v159, 0
    v_dot2_f32_bf16 v172, v135, v154, v172
    v_dot2_f32_bf16 v173, v135, v158, v173
    v_dot2_f32_bf16 v174, v136, v154, v174
    v_dot2_f32_bf16 v175, v136, v158, v175
    v_dot2_f32_bf16 v172, v136, v153, v172
    v_dot2_f32_bf16 v173, v136, v157, v173
    s_waitcnt vmcnt(10)
    v_dot2_f32_bf16 v174, v137, v153, v174
    v_dot2_f32_bf16 v175, v137, v157, v175
    v_dot2_f32_bf16 v172, v137, v152, v172
    v_dot2_f32_bf16 v173, v137, v156, v173
    s_waitcnt vmcnt(8)
    v_dot2_f32_bf16 v174, v138, v152, v174
    v_dot2_f32_bf16 v175, v138, v156, v175
    v_lshlrev_b32 v188, 16, v145
    v_and_b32 v189, s71, v145
    s_waitcnt vmcnt(7)
    v_lshlrev_b32 v190, 16, v146
    v_and_b32_e64 v191, s71, v146
    v_pk_mul_f32 v[172:173], v[172:173], v[188:189]
    v_pk_mul_f32 v[174:175], v[174:175], v[190:191]
    v_cvt_pk_bf16_f32 v195, v172, v174
    v_cvt_pk_bf16_f32 v199, v173, v175
    ds_write_b128 v228, v[192:195] offset:9472
    ds_write_b128 v228, v[196:199] offset:9600
    s_waitcnt lgkmcnt(0)
    s_barrier
    ds_read_b128 v[200:203], v224 offset:9472
    ds_read_b128 v[204:207], v225 offset:10496
    s_mov_b32 s64, 0
    s_waitcnt lgkmcnt(1)
    buffer_store_dwordx4 v[200:203], v229, s[24:27], s64 offen sc0 sc1
    s_mov_b32 s64, 33792
    s_waitcnt lgkmcnt(0)
    buffer_store_dwordx4 v[204:207], v229, s[24:27], s64 offen sc0 sc1
    buffer_store_dwordx4 v[108:111], v238, s[24:27], s47 offen sc0 sc1
    s_waitcnt vmcnt(6)
    s_barrier
    s_mov_b32 s54, 0
    s_atomic_add s54, s[24:25], s52 glc
    ds_read_b64 v[40:41], v60 offset:64
    ds_read_b64 v[38:39], v60 offset:56
    ds_read_b64 v[36:37], v60 offset:48
    ds_read_b64 v[34:35], v60 offset:40
    ds_read_b64 v[32:33], v60 offset:32
    ds_read_b64 v[30:31], v60 offset:24
    ds_read_b64 v[28:29], v60 offset:16
    ds_read_b64 v[26:27], v60 offset:8
    ds_read_b64 v[24:25], v60 offset:0
    ds_read_b64 v[58:59], v60 offset:576
    ds_read_b64 v[56:57], v60 offset:568
    buffer_load_dword a232, v73, s[28:31], s68 offen
    ds_read_b64 v[54:55], v60 offset:560
    ds_read_b64 v[52:53], v60 offset:552
    ds_read_b64 v[50:51], v60 offset:544
    ds_read_b64 v[48:49], v60 offset:536
    ds_read_b64 v[46:47], v60 offset:528
    ds_read_b64 v[44:45], v60 offset:520
    ds_read_b64 v[42:43], v60 offset:512
    s_nop 0
    s_waitcnt lgkmcnt(9)
    v_perm_b32 v128, v40, v39, v61
    v_perm_b32 v129, v39, v38, v61
    v_perm_b32 v130, v38, v37, v61
    v_perm_b32 v131, v37, v36, v61
    v_perm_b32 v132, v36, v35, v61
    v_perm_b32 v133, v35, v34, v61
    v_perm_b32 v134, v34, v33, v61
    v_perm_b32 v135, v33, v32, v61
    v_perm_b32 v136, v32, v31, v61
    v_perm_b32 v137, v31, v30, v61
    v_perm_b32 v138, v30, v29, v61
    v_perm_b32 v139, v29, v28, v61
    v_perm_b32 v140, v28, v27, v61
    v_perm_b32 v141, v27, v26, v61
    v_perm_b32 v142, v26, v25, v61
    v_perm_b32 v143, v25, v24, v61
    s_lshl_b32 s48, s62, 16
    s_and_b32 s49, s62, s71
    s_nop 0
    s_add_u32 s47, s61, 16
    ds_read_b64 v[40:41], v60 offset:1088
    ds_read_b64 v[38:39], v60 offset:1080
    ds_read_b64 v[36:37], v60 offset:1072
    ds_read_b64 v[34:35], v60 offset:1064
    ds_read_b64 v[32:33], v60 offset:1056
    ds_read_b64 v[30:31], v60 offset:1048
    ds_read_b64 v[28:29], v60 offset:1040
    ds_read_b64 v[26:27], v60 offset:1032
    ds_read_b64 v[24:25], v60 offset:1024
    s_nop 0
    s_waitcnt lgkmcnt(9)
    v_perm_b32 v144, v58, v57, v61
    v_perm_b32 v145, v57, v56, v61
    v_perm_b32 v146, v56, v55, v61
    v_perm_b32 v147, v55, v54, v61
    v_perm_b32 v148, v54, v53, v61
    v_perm_b32 v149, v53, v52, v61
    v_perm_b32 v150, v52, v51, v61
    v_perm_b32 v151, v51, v50, v61
    v_perm_b32 v152, v50, v49, v61
    v_perm_b32 v153, v49, v48, v61
    v_perm_b32 v154, v48, v47, v61
    v_perm_b32 v155, v47, v46, v61
    v_perm_b32 v156, v46, v45, v61
    v_perm_b32 v157, v45, v44, v61
    v_perm_b32 v158, v44, v43, v61
    v_perm_b32 v159, v43, v42, v61
    buffer_load_dword a233, v73, s[32:35], s68 offen offset:1024
    ds_read_b64 v[58:59], v60 offset:1600
    ds_read_b64 v[56:57], v60 offset:1592
    ds_read_b64 v[54:55], v60 offset:1584
    ds_read_b64 v[52:53], v60 offset:1576
    ds_read_b64 v[50:51], v60 offset:1568
    ds_read_b64 v[48:49], v60 offset:1560
    ds_read_b64 v[46:47], v60 offset:1552
    ds_read_b64 v[44:45], v60 offset:1544
    ds_read_b64 v[42:43], v60 offset:1536
    s_nop 0
    s_waitcnt lgkmcnt(9)
    v_perm_b32 v160, v40, v39, v61
    v_perm_b32 v161, v39, v38, v61
    v_perm_b32 v162, v38, v37, v61
    v_perm_b32 v163, v37, v36, v61
    v_perm_b32 v164, v36, v35, v61
    v_perm_b32 v165, v35, v34, v61
    v_perm_b32 v166, v34, v33, v61
    v_perm_b32 v167, v33, v32, v61
    v_perm_b32 v168, v32, v31, v61
    v_perm_b32 v169, v31, v30, v61
    v_perm_b32 v170, v30, v29, v61
    v_perm_b32 v171, v29, v28, v61
    v_perm_b32 v172, v28, v27, v61
    v_perm_b32 v173, v27, v26, v61
    v_perm_b32 v174, v26, v25, v61
    v_perm_b32 v175, v25, v24, v61
    ds_read_b64 v[40:41], v60 offset:2112
    ds_read_b64 v[38:39], v60 offset:2104
    ds_read_b64 v[36:37], v60 offset:2096
    ds_read_b64 v[34:35], v60 offset:2088
    ds_read_b64 v[32:33], v60 offset:2080
    ds_read_b64 v[30:31], v60 offset:2072
    ds_read_b64 v[28:29], v60 offset:2064
    ds_read_b64 v[26:27], v60 offset:2056
    ds_read_b64 v[24:25], v60 offset:2048
    s_nop 0
    s_waitcnt lgkmcnt(9)
    v_perm_b32 v176, v58, v57, v61
    v_perm_b32 v177, v57, v56, v61
    v_perm_b32 v178, v56, v55, v61
    v_perm_b32 v179, v55, v54, v61
    v_perm_b32 v180, v54, v53, v61
    v_perm_b32 v181, v53, v52, v61
    v_perm_b32 v182, v52, v51, v61
    v_perm_b32 v183, v51, v50, v61
    v_perm_b32 v184, v50, v49, v61
    v_perm_b32 v185, v49, v48, v61
    v_perm_b32 v186, v48, v47, v61
    v_perm_b32 v187, v47, v46, v61
    v_perm_b32 v188, v46, v45, v61
    v_perm_b32 v189, v45, v44, v61
    v_perm_b32 v190, v44, v43, v61
    v_perm_b32 v191, v43, v42, v61
    s_waitcnt lgkmcnt(0)
    s_sub_u32 s54, s54, s61
    s_cmp_le_u32 s54, 16
    s_cbranch_scc0 L_retry_3
L_ok_2:
    s_waitcnt vmcnt(3)
    s_barrier
    s_atomic_add s3, s[24:25], s52
    s_add_u32 s68, s68, 7168
    buffer_load_dword a234, v73, s[28:31], s68 offen
    ds_read_b64 v[58:59], v60 offset:2624
    ds_read_b64 v[56:57], v60 offset:2616
    ds_read_b64 v[54:55], v60 offset:2608
    ds_read_b64 v[52:53], v60 offset:2600
    ds_read_b64 v[50:51], v60 offset:2592
    s_add_u32 m0, s44, 0
    s_mov_b32 s45, 0
    ds_read_b64 v[48:49], v60 offset:2584
    ds_read_b64 v[46:47], v60 offset:2576
    ds_read_b64 v[44:45], v60 offset:2568
    ds_read_b64 v[42:43], v60 offset:2560
    buffer_load_dwordx4 v65, s[28:31], s45 offen  lds
    v_perm_b32 v192, v40, v39, v61
    v_perm_b32 v193, v39, v38, v61
    v_perm_b32 v194, v38, v37, v61
    v_perm_b32 v195, v37, v36, v61
    v_perm_b32 v196, v36, v35, v61
    buffer_load_dwordx4 v65, s[32:35], s45 offen offset:1024  lds
    v_perm_b32 v197, v35, v34, v61
    v_perm_b32 v198, v34, v33, v61
    v_perm_b32 v199, v33, v32, v61
    v_perm_b32 v200, v32, v31, v61
    v_perm_b32 v201, v31, v30, v61
    v_perm_b32 v202, v30, v29, v61
    v_perm_b32 v203, v29, v28, v61
    v_perm_b32 v204, v28, v27, v61
    v_perm_b32 v205, v27, v26, v61
    v_perm_b32 v206, v26, v25, v61
    v_perm_b32 v207, v25, v24, v61
    s_nop 0
    s_mov_b32 s54, 0
    s_atomic_add s54, s[24:25], s53 glc
    ds_read_b64 v[40:41], v60 offset:3136
    ds_read_b64 v[38:39], v60 offset:3128
    ds_read_b64 v[36:37], v60 offset:3120
    ds_read_b64 v[34:35], v60 offset:3112
    ds_read_b64 v[32:33], v60 offset:3104
    s_add_u32 m0, s44, 8192
    s_mov_b32 s45, 57344
    ds_read_b64 v[30:31], v60 offset:3096
    ds_read_b64 v[28:29], v60 offset:3088
    ds_read_b64 v[26:27], v60 offset:3080
    ds_read_b64 v[24:25], v60 offset:3072
    s_nop 0
    s_waitcnt lgkmcnt(9)
    buffer_load_dwordx4 v65, s[28:31], s45 offen  lds
    v_perm_b32 v208, v58, v57, v61
    v_perm_b32 v209, v57, v56, v61
    v_perm_b32 v210, v56, v55, v61
    v_perm_b32 v211, v55, v54, v61
    v_perm_b32 v212, v54, v53, v61
    buffer_load_dwordx4 v65, s[32:35], s45 offen offset:1024  lds
    v_perm_b32 v213, v53, v52, v61
    v_perm_b32 v214, v52, v51, v61
    v_perm_b32 v215, v51, v50, v61
    v_perm_b32 v216, v50, v49, v61
    v_perm_b32 v217, v49, v48, v61
    v_perm_b32 v218, v48, v47, v61
    v_perm_b32 v219, v47, v46, v61
    v_perm_b32 v220, v46, v45, v61
    v_perm_b32 v221, v45, v44, v61
    v_perm_b32 v222, v44, v43, v61
    v_perm_b32 v223, v43, v42, v61
    buffer_load_dword a235, v73, s[32:35], s68 offen offset:1024
    ds_read_b64 v[58:59], v60 offset:3648
    ds_read_b64 v[56:57], v60 offset:3640
    ds_read_b64 v[54:55], v60 offset:3632
    ds_read_b64 v[52:53], v60 offset:3624
    ds_read_b64 v[50:51], v60 offset:3616
    s_add_u32 m0, s44, 16384
    s_mov_b32 s45, 114688
    ds_read_b64 v[48:49], v60 offset:3608
    ds_read_b64 v[46:47], v60 offset:3600
    ds_read_b64 v[44:45], v60 offset:3592
    ds_read_b64 v[42:43], v60 offset:3584
    s_nop 0
    s_waitcnt lgkmcnt(9)
    buffer_load_dwordx4 v65, s[28:31], s45 offen  lds
    v_perm_b32 v224, v40, v39, v61
    v_perm_b32 v225, v39, v38, v61
    v_perm_b32 v226, v38, v37, v61
    v_perm_b32 v227, v37, v36, v61
    v_perm_b32 v228, v36, v35, v61
    buffer_load_dwordx4 v65, s[32:35], s45 offen offset:1024  lds
    v_perm_b32 v229, v35, v34, v61
    v_perm_b32 v230, v34, v33, v61
    v_perm_b32 v231, v33, v32, v61
    v_perm_b32 v232, v32, v31, v61
    v_perm_b32 v233, v31, v30, v61
    v_perm_b32 v234, v30, v29, v61
    v_perm_b32 v235, v29, v28, v61
    v_perm_b32 v236, v28, v27, v61
    v_perm_b32 v237, v27, v26, v61
    v_perm_b32 v238, v26, v25, v61
    v_perm_b32 v239, v25, v24, v61
    s_cmp_eq_u32 s54, s47
    s_cbranch_scc0 L_retry_5
L_ok_4:
    s_add_u32 m0, s55, 0
    s_nop 0
    buffer_load_dwordx4 v62, s[24:27], s46 offen offset:0 sc1 lds
    s_add_u32 m0, s55, 2304
    s_nop 0
    buffer_load_dwordx4 v62, s[24:27], s46 offen offset:64 sc1 lds
    ds_read_b32 v63, v14
    s_waitcnt lgkmcnt(1)
    v_perm_b32 v240, v58, v57, v61
    v_perm_b32 v241, v57, v56, v61
    v_perm_b32 v242, v56, v55, v61
    v_perm_b32 v243, v55, v54, v61
    s_add_u32 m0, s44, 24576
    s_mov_b32 s45, 172032
    v_perm_b32 v244, v54, v53, v61
    v_perm_b32 v245, v53, v52, v61
    v_perm_b32 v246, v52, v51, v61
    v_perm_b32 v247, v51, v50, v61
    v_perm_b32 v248, v50, v49, v61
    buffer_load_dwordx4 v65, s[28:31], s45 offen  lds
    v_perm_b32 v249, v49, v48, v61
    v_perm_b32 v250, v48, v47, v61
    v_perm_b32 v251, v47, v46, v61
    v_perm_b32 v252, v46, v45, v61
    v_perm_b32 v253, v45, v44, v61
    buffer_load_dwordx4 v65, s[32:35], s45 offen offset:1024  lds
    v_perm_b32 v254, v44, v43, v61
    v_perm_b32 v255, v43, v42, v61
    s_add_u32 m0, s44, 32768
    s_mov_b32 s45, 229376
    s_and_b32 s64, s59, 3
    s_lshl_b32 s10, s58, 2
    s_add_u32 s10, s10, s64
    s_lshr_b32 s11, s59, 2
    s_lshl_b32 s11, s11, 7
    s_mul_i32 s8, s60, 401408
    s_add_u32 s8, s8, s11
    s_mul_i32 s9, s60, 24576
    buffer_load_dwordx4 v65, s[28:31], s45 offen  lds
    s_add_u32 s9, s9, 65536
    v_lshrrev_b32_e64 v124, 3, v1
    v_mul_u32_u24 v125, 896, v124
    v_and_b32_e64 v126, 1, v1
    v_lshl_add_u32 v125, v126, 4, v125
    v_bfe_u32 v126, v1, 1, 2
    v_bfe_u32 v127, v1, 4, 1
    v_xor_b32_e64 v126, v126, v127
    buffer_load_dwordx4 v65, s[32:35], s45 offen offset:1024  lds
    v_lshl_add_u32 v20, v126, 5, v125
    v_xor_b32_e64 v126, 2, v126
    v_lshl_add_u32 v21, v126, 5, v125
    v_add_u32 v21, 6144, v21
    v_add_u32 v22, 12288, v20
    v_add_u32 v23, 12288, v21
    v_lshrrev_b32_e64 v124, 4, v1
    v_bfe_u32 v125, v1, 2, 2
    s_add_u32 m0, s44, 40960
    s_mov_b32 s45, 286720
    v_lshl_add_u32 v126, v124, 3, v125
    v_lshlrev_b32 v126, 7, v126
    v_and_b32 v127, 3, v1
    v_lshl_add_u32 v126, v127, 3, v126
    v_add_u32_e64 v126, s9, v126
    v_bfe_u32 v127, v1, 3, 2
    v_xor_b32_e64 v124, 0, v127
    v_lshl_add_u32 v24, v124, 5, v126
    buffer_load_dwordx4 v65, s[28:31], s45 offen  lds
    v_xor_b32_e64 v124, 1, v127
    v_lshl_add_u32 v25, v124, 5, v126
    v_xor_b32_e64 v124, 2, v127
    v_lshl_add_u32 v26, v124, 5, v126
    v_xor_b32_e64 v124, 3, v127
    v_lshl_add_u32 v27, v124, 5, v126
    s_mov_b32 s66, s79
    s_lshl_b32 s67, s66, 2
    buffer_load_dwordx4 v65, s[32:35], s45 offen offset:1024  lds
    s_add_u32 s4, s67, s60
    s_mul_i32 s4, s4, 256
    s_add_u32 s4, s4, 19922944
    s_mul_i32 s5, s66, 28672
    s_add_u32 s5, s5, 2883584
    s_lshl_b32 s64, s80, 2
    s_add_u32 s64, s64, s60
    s_mul_i32 s65, s66, 112
    s_add_u32 s65, s65, s64
    s_lshl_b32 s6, s65, 10
    s_add_u32 s6, s6, 12189696
    s_mul_i32 s64, s64, 4682
    s_lshr_b32 s64, s64, 16
    s_add_u32 s64, s64, s67
    s_mul_i32 s7, s64, 256
    s_add_u32 s7, s7, 20004864
    s_add_u32 s76, s61, 2
    s_add_u32 s77, s61, 14
    s_lshl_b32 s13, s60, 10
    s_lshl_b32 s65, s60, 3
    v_lshrrev_b32 v124, 3, v1
    v_add_u32_e64 v124, s65, v124
    v_mul_u32_u24 v125, 896, v124
    v_bfe_u32 v124, v124, 1, 3
    v_xor_b32 v124, v124, v1
    v_and_b32 v124, 7, v124
    v_lshl_add_u32 v5, v124, 4, v125
    v_and_b32 v124, 15, v1
    v_lshlrev_b32 v125, 7, v124
    v_bfe_u32 v124, v1, 1, 3
    v_lshrrev_b32 v126, 4, v1
    v_xor_b32 v124, v124, v126
    v_lshl_add_u32 v16, v124, 4, v125
    v_xor_b32 v17, 64, v16
    v_lshlrev_b32 v12, 4, v1
    v_add_u32 v18, 57344, v12
    s_mul_i32 s64, s60, 14
    s_mul_i32 s65, s10, 56
    s_add_u32 s65, s65, s64
    s_lshl_b32 s15, s65, 10
    s_add_u32 s15, s15, 12189696
    s_lshr_b32 s65, s10, 1
    s_lshl_b32 s65, s65, 2
    s_add_u32 s65, s65, s60
    s_mul_i32 s16, s65, 256
    s_add_u32 s16, s16, 20004864
    s_mul_i32 s64, s60, 4352
    v_and_b32 v124, 15, v1
    v_mul_u32_u24 v13, 272, v124
    v_lshrrev_b32_e64 v125, 4, v1
    v_lshl_add_u32 v13, v125, 4, v13
    v_add_u32 v13, s64, v13
    v_lshrrev_b32 v125, 4, v0
    v_mul_u32_u24 v14, 272, v125
    v_lshl_add_u32 v14, v124, 4, v14
    v_lshl_add_u32 v126, v124, 3, s11
    v_mul_u32_u24 v15, 896, v125
    v_add_u32 v15, v15, v126
    v_mov_b32 v7, v126
    s_mul_i32 s17, s10, 14336
    s_lshl_b32 s64, s10, 1
    s_lshr_b32 s65, s60, 1
    s_add_u32 s64, s64, s65
    s_mul_i32 s64, s64, 256
    s_add_u32 s19, s64, 19988480
    v_lshlrev_b32 v3, 4, v1
    s_movk_i32 s72, 4096
    s_movk_i32 s73, 8192
    s_movk_i32 s74, 12288
    s_mov_b32 s75, 725376
    v_add_u32 v8, s15, v3
    v_add_u32 v9, 1835008, v8
    v_add_u32 v10, 3670016, v8
    v_add_u32 v11, 5505024, v8
    s_waitcnt vmcnt(6)
    s_barrier
    ds_read_b128 a[128:131], v68 offset:0
    ds_read_b128 a[132:135], v68 offset:2368
    ds_read_b128 a[136:139], v68 offset:16
    ds_read_b128 a[140:143], v68 offset:2384
    ds_read_b128 a[144:147], v68 offset:256
    ds_read_b128 a[148:151], v68 offset:2624
    ds_read_b128 a[152:155], v68 offset:272
    ds_read_b128 a[156:159], v68 offset:2640
    s_waitcnt lgkmcnt(7)
    v_mfma_f32_16x16x32_bf16 v[88:91], v[128:131], a[128:131], 0
    v_mfma_f32_16x16x32_bf16 v[92:95], v[144:147], a[128:131], 0
    ds_read_b128 a[160:163], v68 offset:512
    s_waitcnt lgkmcnt(7)
    v_mfma_f32_16x16x32_bf16 v[88:91], v[132:135], a[132:135], v[88:91]
    ds_read_b128 a[164:167], v68 offset:2880
    v_mfma_f32_16x16x32_bf16 v[92:95], v[148:151], a[132:135], v[92:95]
    ds_read_b128 a[168:171], v68 offset:528
    s_waitcnt lgkmcnt(8)
    v_mfma_f32_16x16x32_bf16 v[88:91], v[136:139], a[136:139], v[88:91]
    ds_read_b128 a[172:175], v68 offset:2896
    v_mfma_f32_16x16x32_bf16 v[92:95], v[152:155], a[136:139], v[92:95]
    ds_read_b128 a[176:179], v68 offset:768
    s_waitcnt lgkmcnt(9)
    v_mfma_f32_16x16x32_bf16 v[88:91], v[140:143], a[140:143], v[88:91]
    ds_read_b128 a[180:183], v68 offset:3136
    v_mfma_f32_16x16x32_bf16 v[92:95], v[156:159], a[140:143], v[92:95]
    ds_read_b32 v112, v64 offset:256
    ds_read_b32 v113, v64 offset:4992
    s_waitcnt lgkmcnt(11)
    v_mfma_f32_16x16x32_bf16 v[92:95], v[128:131], a[144:147], v[92:95]
    ds_read_b128 a[184:187], v68 offset:784
    s_waitcnt lgkmcnt(11)
    v_mfma_f32_16x16x32_bf16 v[92:95], v[132:135], a[148:151], v[92:95]
    ds_read_b128 a[188:191], v68 offset:3152
    s_waitcnt lgkmcnt(11)
    v_mfma_f32_16x16x32_bf16 v[92:95], v[136:139], a[152:155], v[92:95]
    ds_read_b64_tr_b16 a[0:1], v66 offset:0
    s_waitcnt lgkmcnt(11)
    v_mfma_f32_16x16x32_bf16 v[92:95], v[140:143], a[156:159], v[92:95]
    ds_read_b64_tr_b16 a[2:3], v66 offset:2048
    v_mfma_f32_16x16x32_bf16 v[96:99], v[160:163], a[128:131], 0
    s_add_u32 m0, s44, 49152
    s_mov_b32 s45, 344064
    buffer_load_dwordx4 v65, s[28:31], s45 offen  lds
    v_mfma_f32_16x16x32_bf16 v[100:103], v[176:179], a[128:131], 0
    ds_read_b64_tr_b16 a[4:5], v66 offset:8
    v_mfma_f32_16x16x32_bf16 v[96:99], v[164:167], a[132:135], v[96:99]
    ds_write_b128 v69, v[88:91] offset:9472
    v_mfma_f32_16x16x32_bf16 v[100:103], v[180:183], a[132:135], v[100:103]
    ds_read_b64_tr_b16 a[6:7], v66 offset:2056
    v_mfma_f32_16x16x32_bf16 v[96:99], v[168:171], a[136:139], v[96:99]
    ds_write_b128 v69, v[92:95] offset:10752
    v_mfma_f32_16x16x32_bf16 v[100:103], v[184:187], a[136:139], v[100:103]
    s_waitcnt lgkmcnt(9)
    v_lshlrev_b32_e32 v116, 16, v112
    s_waitcnt lgkmcnt(8)
    v_lshlrev_b32_e32 v118, 16, v113
    v_and_b32_e64 v117, s71, v112
    v_mfma_f32_16x16x32_bf16 v[96:99], v[172:175], a[140:143], v[96:99]
    buffer_load_dwordx4 v65, s[32:35], s45 offen offset:1024  lds
    v_and_b32_e64 v119, s71, v113
    v_mfma_f32_16x16x32_bf16 v[100:103], v[188:191], a[140:143], v[100:103]
    ds_read_b64_tr_b16 a[8:9], v66 offset:1024
    v_mfma_f32_16x16x32_bf16 v[96:99], v[144:147], a[144:147], v[96:99]
    s_waitcnt lgkmcnt(0)
    s_barrier
    ds_read_b64 v[104:105], v70 offset:9472
    v_mfma_f32_16x16x32_bf16 v[100:103], v[160:163], a[144:147], v[100:103]
    ds_read_b64 v[106:107], v70 offset:12032
    ds_read_b64 v[108:109], v70 offset:14592
    v_mfma_f32_16x16x32_bf16 v[96:99], v[148:151], a[148:151], v[96:99]
    ds_read_b64 v[110:111], v70 offset:17152
    s_add_u32 m0, s44, 57344
    s_mov_b32 s45, 401408
    v_mfma_f32_16x16x32_bf16 v[100:103], v[164:167], a[148:151], v[100:103]
    buffer_load_dwordx4 v65, s[28:31], s45 offen  lds
    v_mfma_f32_16x16x32_bf16 v[96:99], v[152:155], a[152:155], v[96:99]
    ds_read_b64_tr_b16 a[10:11], v66 offset:3072
    v_mfma_f32_16x16x32_bf16 v[100:103], v[168:171], a[152:155], v[100:103]
    ds_read_b64_tr_b16 a[12:13], v66 offset:1032
    v_mfma_f32_16x16x32_bf16 v[96:99], v[156:159], a[156:159], v[96:99]
    s_waitcnt lgkmcnt(2)
    s_mov_b32 s64, 0
    v_fma_f32 v104, v116, s48, v104
    v_fma_f32 v105, v117, s48, v105
    v_mfma_f32_16x16x32_bf16 v[100:103], v[172:175], a[156:159], v[100:103]
    v_fma_f32 v108, v118, s49, v108
    v_fma_f32 v109, v119, s49, v109
    v_add_f32_e64 v104, v104, v106
    v_mfma_f32_16x16x32_bf16 v[96:99], v[128:131], a[160:163], v[96:99]
    v_add_f32_e64 v105, v105, v107
    v_add_f32_e64 v108, v108, v110
    v_add_f32_e64 v109, v109, v111
    v_mfma_f32_16x16x32_bf16 v[100:103], v[144:147], a[160:163], v[100:103]
    v_cvt_pk_bf16_f32 v120, v104, v108
    v_cvt_pk_bf16_f32 v121, v105, v109
    v_mfma_f32_16x16x32_bf16 v[96:99], v[132:135], a[164:167], v[96:99]
    buffer_load_dwordx4 v65, s[32:35], s45 offen offset:1024  lds
    v_mfma_f32_16x16x32_bf16 v[100:103], v[148:151], a[164:167], v[100:103]
    ds_read_b64_tr_b16 a[14:15], v66 offset:3080
    v_mfma_f32_16x16x32_bf16 v[96:99], v[136:139], a[168:171], v[96:99]
    v_mfma_f32_16x16x32_bf16 v[100:103], v[152:155], a[168:171], v[100:103]
    v_mfma_f32_16x16x32_bf16 v[96:99], v[140:143], a[172:175], v[96:99]
    s_add_u32 m0, s44, 65536
    s_mov_b32 s45, 458752
    buffer_load_dwordx4 v65, s[28:31], s45 offen  lds
    v_mfma_f32_16x16x32_bf16 v[100:103], v[156:159], a[172:175], v[100:103]
    ds_read_b32 v112, v64 offset:768
    ds_read_b32 v113, v64 offset:5504
    v_mfma_f32_16x16x32_bf16 v[100:103], v[128:131], a[176:179], v[100:103]
    v_mfma_f32_16x16x32_bf16 v[100:103], v[132:135], a[180:183], v[100:103]
    v_mfma_f32_16x16x32_bf16 v[100:103], v[136:139], a[184:187], v[100:103]
    v_mfma_f32_16x16x32_bf16 v[100:103], v[140:143], a[188:191], v[100:103]
    buffer_load_dwordx4 v65, s[32:35], s45 offen offset:1024  lds
    v_mfma_f32_16x16x32_bf16 v[88:91], v[192:195], a[128:131], 0
    v_mfma_f32_16x16x32_bf16 v[92:95], v[208:211], a[128:131], 0
    v_mfma_f32_16x16x32_bf16 v[88:91], v[196:199], a[132:135], v[88:91]
    ds_write_b128 v69, v[96:99] offset:19712
    v_mfma_f32_16x16x32_bf16 v[92:95], v[212:215], a[132:135], v[92:95]
    s_add_u32 m0, s44, 73728
    s_mov_b32 s45, 516096
    buffer_load_dwordx4 v65, s[28:31], s45 offen  lds
    v_mfma_f32_16x16x32_bf16 v[88:91], v[200:203], a[136:139], v[88:91]
    ds_write_b128 v69, v[100:103] offset:20992
    v_mfma_f32_16x16x32_bf16 v[92:95], v[216:219], a[136:139], v[92:95]
    s_waitcnt lgkmcnt(3)
    v_lshlrev_b32_e32 v116, 16, v112
    s_waitcnt lgkmcnt(2)
    v_lshlrev_b32_e32 v118, 16, v113
    v_and_b32_e64 v117, s71, v112
    v_mfma_f32_16x16x32_bf16 v[88:91], v[204:207], a[140:143], v[88:91]
    v_and_b32_e64 v119, s71, v113
    v_mfma_f32_16x16x32_bf16 v[92:95], v[220:223], a[140:143], v[92:95]
    v_mfma_f32_16x16x32_bf16 v[88:91], v[176:179], a[144:147], v[88:91]
    s_waitcnt vmcnt(3)
    s_waitcnt lgkmcnt(0)
    s_barrier
    v_mfma_f32_16x16x32_bf16 v[92:95], v[192:195], a[144:147], v[92:95]
    ds_read_b64 v[104:105], v70 offset:19712
    ds_read_b64 v[106:107], v70 offset:22272
    v_mfma_f32_16x16x32_bf16 v[88:91], v[180:183], a[148:151], v[88:91]
    ds_read_b64 v[108:109], v70 offset:24832
    ds_read_b64 v[110:111], v70 offset:27392
    v_mfma_f32_16x16x32_bf16 v[92:95], v[196:199], a[148:151], v[92:95]
    buffer_load_dwordx4 v65, s[32:35], s45 offen offset:1024  lds
    v_mfma_f32_16x16x32_bf16 v[88:91], v[184:187], a[152:155], v[88:91]
    ds_read_b64_tr_b16 a[16:17], v66 offset:16384
    v_mfma_f32_16x16x32_bf16 v[92:95], v[200:203], a[152:155], v[92:95]
    ds_read_b64_tr_b16 a[18:19], v66 offset:18432
    v_mfma_f32_16x16x32_bf16 v[88:91], v[188:191], a[156:159], v[88:91]
    s_waitcnt lgkmcnt(2)
    s_mov_b32 s64, 0
    v_fma_f32 v104, v116, s48, v104
    v_fma_f32 v105, v117, s48, v105
    v_mfma_f32_16x16x32_bf16 v[92:95], v[204:207], a[156:159], v[92:95]
    s_add_u32 m0, s44, 81920
    v_fma_f32 v108, v118, s49, v108
    v_fma_f32 v109, v119, s49, v109
    v_add_f32_e32 v104, v104, v106
    v_mfma_f32_16x16x32_bf16 v[88:91], v[160:163], a[160:163], v[88:91]
    s_mov_b32 s45, 573440
    v_add_f32_e64 v105, v105, v107
    v_add_f32_e64 v108, v108, v110
    v_add_f32_e64 v109, v109, v111
    v_mfma_f32_16x16x32_bf16 v[92:95], v[176:179], a[160:163], v[92:95]
    v_cvt_pk_bf16_f32 v122, v104, v108
    v_cvt_pk_bf16_f32 v123, v105, v109
    v_mfma_f32_16x16x32_bf16 v[88:91], v[164:167], a[164:167], v[88:91]
    buffer_store_dwordx4 v[120:123], v71, s[24:27], s64 offen sc0 sc1
    v_mfma_f32_16x16x32_bf16 v[92:95], v[180:183], a[164:167], v[92:95]
    ds_read_b128 a[192:195], v68 offset:1024
    buffer_load_dwordx4 v65, s[28:31], s45 offen  lds
    v_mfma_f32_16x16x32_bf16 v[88:91], v[168:171], a[168:171], v[88:91]
    ds_read_b128 a[196:199], v68 offset:3392
    v_mfma_f32_16x16x32_bf16 v[92:95], v[184:187], a[168:171], v[92:95]
    ds_read_b128 a[200:203], v68 offset:1040
    v_mfma_f32_16x16x32_bf16 v[88:91], v[172:175], a[172:175], v[88:91]
    ds_read_b128 a[204:207], v68 offset:3408
    v_mfma_f32_16x16x32_bf16 v[92:95], v[188:191], a[172:175], v[92:95]
    ds_read_b128 a[208:211], v68 offset:1280
    v_mfma_f32_16x16x32_bf16 v[88:91], v[144:147], a[176:179], v[88:91]
    ds_read_b128 a[212:215], v68 offset:3648
    buffer_load_dwordx4 v65, s[32:35], s45 offen offset:1024  lds
    v_mfma_f32_16x16x32_bf16 v[92:95], v[160:163], a[176:179], v[92:95]
    ds_read_b128 a[216:219], v68 offset:1296
    buffer_load_dword v6, v72, s[36:39], s81 offen
    v_mfma_f32_16x16x32_bf16 v[88:91], v[148:151], a[180:183], v[88:91]
    ds_read_b128 a[220:223], v68 offset:3664
    v_mfma_f32_16x16x32_bf16 v[92:95], v[164:167], a[180:183], v[92:95]
    ds_read_b64_tr_b16 a[20:21], v66 offset:16392
    v_mfma_f32_16x16x32_bf16 v[88:91], v[152:155], a[184:187], v[88:91]
    ds_read_b64_tr_b16 a[22:23], v66 offset:18440
    v_mfma_f32_16x16x32_bf16 v[92:95], v[168:171], a[184:187], v[92:95]
    s_add_u32 m0, s44, 90112
    s_mov_b32 s45, 630784
    buffer_load_dwordx4 v65, s[28:31], s45 offen  lds
    v_mfma_f32_16x16x32_bf16 v[88:91], v[156:159], a[188:191], v[88:91]
    ds_read_b64_tr_b16 a[24:25], v66 offset:17408
    v_mfma_f32_16x16x32_bf16 v[92:95], v[172:175], a[188:191], v[92:95]
    ds_read_b64_tr_b16 a[26:27], v66 offset:19456
    s_waitcnt lgkmcnt(11)
    v_mfma_f32_16x16x32_bf16 v[88:91], v[128:131], a[192:195], v[88:91]
    ds_read_b64_tr_b16 a[28:29], v66 offset:17416
    v_mfma_f32_16x16x32_bf16 v[92:95], v[144:147], a[192:195], v[92:95]
    ds_read_b64_tr_b16 a[30:31], v66 offset:19464
    s_waitcnt lgkmcnt(12)
    v_mfma_f32_16x16x32_bf16 v[88:91], v[132:135], a[196:199], v[88:91]
    buffer_load_dwordx4 v65, s[32:35], s45 offen offset:1024  lds
    v_mfma_f32_16x16x32_bf16 v[92:95], v[148:151], a[196:199], v[92:95]
    ds_read_b64_tr_b16 a[32:33], v66 offset:32768
    s_waitcnt lgkmcnt(12)
    v_mfma_f32_16x16x32_bf16 v[88:91], v[136:139], a[200:203], v[88:91]
    ds_read_b64_tr_b16 a[34:35], v66 offset:34816
    v_mfma_f32_16x16x32_bf16 v[92:95], v[152:155], a[200:203], v[92:95]
    ds_read_b64_tr_b16 a[36:37], v66 offset:32776
    s_waitcnt lgkmcnt(13)
    v_mfma_f32_16x16x32_bf16 v[88:91], v[140:143], a[204:207], v[88:91]
    s_add_u32 m0, s44, 98304
    s_mov_b32 s45, 688128
    buffer_load_dwordx4 v65, s[28:31], s45 offen  lds
    v_mfma_f32_16x16x32_bf16 v[92:95], v[156:159], a[204:207], v[92:95]
    ds_read_b32 v112, v64 offset:1280
    ds_read_b32 v113, v64 offset:6016
    s_waitcnt lgkmcnt(14)
    v_mfma_f32_16x16x32_bf16 v[92:95], v[128:131], a[208:211], v[92:95]
    ds_read_b64_tr_b16 a[38:39], v66 offset:34824
    s_waitcnt lgkmcnt(14)
    v_mfma_f32_16x16x32_bf16 v[92:95], v[132:135], a[212:215], v[92:95]
    ds_read_b64_tr_b16 a[40:41], v66 offset:33792
    s_waitcnt lgkmcnt(14)
    v_mfma_f32_16x16x32_bf16 v[92:95], v[136:139], a[216:219], v[92:95]
    ds_read_b64_tr_b16 a[42:43], v66 offset:35840
    s_waitcnt lgkmcnt(14)
    v_mfma_f32_16x16x32_bf16 v[92:95], v[140:143], a[220:223], v[92:95]
    buffer_load_dwordx4 v65, s[32:35], s45 offen offset:1024  lds
    v_mfma_f32_16x16x32_bf16 v[96:99], v[224:227], a[128:131], 0
    s_add_u32 s55, s52, 16384
    s_waitcnt vmcnt(7)
    s_atomic_add s3, s[24:25], s55
    v_mfma_f32_16x16x32_bf16 v[100:103], v[240:243], a[128:131], 0
    ds_read_b64_tr_b16 a[44:45], v66 offset:33800
    v_mfma_f32_16x16x32_bf16 v[96:99], v[228:231], a[132:135], v[96:99]
    ds_write_b128 v69, v[88:91] offset:9472
    v_mfma_f32_16x16x32_bf16 v[100:103], v[244:247], a[132:135], v[100:103]
    s_add_u32 m0, s44, 106496
    s_mov_b32 s45, 745472
    buffer_load_dwordx4 v65, s[28:31], s45 offen  lds
    v_mfma_f32_16x16x32_bf16 v[96:99], v[232:235], a[136:139], v[96:99]
    ds_write_b128 v69, v[92:95] offset:10752
    v_mfma_f32_16x16x32_bf16 v[100:103], v[248:251], a[136:139], v[100:103]
    s_waitcnt lgkmcnt(7)
    v_lshlrev_b32_e64 v116, 16, v112
    s_waitcnt lgkmcnt(6)
    v_lshlrev_b32_e32 v118, 16, v113
    v_and_b32_e64 v117, s71, v112
    v_mfma_f32_16x16x32_bf16 v[96:99], v[236:239], a[140:143], v[96:99]
    v_and_b32_e64 v119, s71, v113
    v_mfma_f32_16x16x32_bf16 v[100:103], v[252:255], a[140:143], v[100:103]
    ds_read_b64_tr_b16 a[46:47], v66 offset:35848
    v_mfma_f32_16x16x32_bf16 v[96:99], v[208:211], a[144:147], v[96:99]
    buffer_load_dwordx4 v65, s[32:35], s45 offen offset:1024  lds
    v_mfma_f32_16x16x32_bf16 v[100:103], v[224:227], a[144:147], v[100:103]
    ds_read_b64_tr_b16 a[48:49], v66 offset:49152
    v_mfma_f32_16x16x32_bf16 v[96:99], v[212:215], a[148:151], v[96:99]
    ds_read_b64_tr_b16 a[50:51], v66 offset:51200
    v_mfma_f32_16x16x32_bf16 v[100:103], v[228:231], a[148:151], v[100:103]
    ds_read_b64_tr_b16 a[52:53], v66 offset:49160
    v_mfma_f32_16x16x32_bf16 v[96:99], v[216:219], a[152:155], v[96:99]
    s_add_u32 m0, s44, 114688
    s_mov_b32 s45, 802816
    buffer_load_dwordx4 v65, s[28:31], s45 offen  lds
    v_mfma_f32_16x16x32_bf16 v[100:103], v[232:235], a[152:155], v[100:103]
    ds_read_b64_tr_b16 a[54:55], v66 offset:51208
    v_mfma_f32_16x16x32_bf16 v[96:99], v[220:223], a[156:159], v[96:99]
    ds_read_b64_tr_b16 a[56:57], v66 offset:50176
    v_mfma_f32_16x16x32_bf16 v[100:103], v[236:239], a[156:159], v[100:103]
    ds_read_b64_tr_b16 a[58:59], v66 offset:52224
    v_mfma_f32_16x16x32_bf16 v[96:99], v[192:195], a[160:163], v[96:99]
    ds_read_b64_tr_b16 a[60:61], v66 offset:50184
    v_mfma_f32_16x16x32_bf16 v[100:103], v[208:211], a[160:163], v[100:103]
    buffer_load_dwordx4 v65, s[32:35], s45 offen offset:1024  lds
    v_mfma_f32_16x16x32_bf16 v[96:99], v[196:199], a[164:167], v[96:99]
    ds_read_b64_tr_b16 a[62:63], v66 offset:52232
    v_mfma_f32_16x16x32_bf16 v[100:103], v[212:215], a[164:167], v[100:103]
    s_waitcnt vmcnt(6)
    ds_read_b32 v63, v14
    s_waitcnt lgkmcnt(1)
    s_barrier
    v_mfma_f32_16x16x32_bf16 v[96:99], v[200:203], a[168:171], v[96:99]
    ds_read_b64 v[104:105], v70 offset:9472
    ds_read_b64 v[106:107], v70 offset:12032
    v_mfma_f32_16x16x32_bf16 v[100:103], v[216:219], a[168:171], v[100:103]
    ds_read_b64 v[108:109], v70 offset:14592
    ds_read_b64 v[110:111], v70 offset:17152
    s_add_u32 m0, s44, 122880
    v_mfma_f32_16x16x32_bf16 v[96:99], v[204:207], a[172:175], v[96:99]
    s_mov_b32 s45, 860160
    buffer_load_dwordx4 v65, s[28:31], s45 offen  lds
    v_mfma_f32_16x16x32_bf16 v[100:103], v[220:223], a[172:175], v[100:103]
    ds_read_b64_tr_b16 a[64:65], v67 offset:0
    v_mfma_f32_16x16x32_bf16 v[96:99], v[176:179], a[176:179], v[96:99]
    ds_read_b64_tr_b16 a[66:67], v67 offset:2048
    v_mfma_f32_16x16x32_bf16 v[100:103], v[192:195], a[176:179], v[100:103]
    s_waitcnt lgkmcnt(2)
    s_mov_b32 s64, 4096
    v_fma_f32 v104, v116, s48, v104
    v_fma_f32 v105, v117, s48, v105
    v_mfma_f32_16x16x32_bf16 v[96:99], v[180:183], a[180:183], v[96:99]
    v_fma_f32 v108, v118, s49, v108
    v_fma_f32 v109, v119, s49, v109
    v_add_f32_e64 v104, v104, v106
    v_mfma_f32_16x16x32_bf16 v[100:103], v[196:199], a[180:183], v[100:103]
    v_add_f32_e64 v105, v105, v107
    v_add_f32_e64 v108, v108, v110
    v_add_f32_e64 v109, v109, v111
    v_mfma_f32_16x16x32_bf16 v[96:99], v[184:187], a[184:187], v[96:99]
    v_cvt_pk_bf16_f32 v120, v104, v108
    v_cvt_pk_bf16_f32 v121, v105, v109
    v_mfma_f32_16x16x32_bf16 v[100:103], v[200:203], a[184:187], v[100:103]
    ds_read_b128 a[224:227], v68 offset:1536
    buffer_load_dwordx4 v65, s[32:35], s45 offen offset:1024  lds
    v_mfma_f32_16x16x32_bf16 v[96:99], v[188:191], a[188:191], v[96:99]
    ds_read_b128 a[228:231], v68 offset:3904
    v_mfma_f32_16x16x32_bf16 v[100:103], v[204:207], a[188:191], v[100:103]
    ds_read_b128 a[232:235], v68 offset:1552
    v_mfma_f32_16x16x32_bf16 v[96:99], v[160:163], a[192:195], v[96:99]
    ds_read_b128 a[236:239], v68 offset:3920
    v_mfma_f32_16x16x32_bf16 v[100:103], v[176:179], a[192:195], v[100:103]
    ds_read_b128 a[240:243], v68 offset:1792
    s_add_u32 m0, s44, 0
    s_mov_b32 s45, 917504
    v_mfma_f32_16x16x32_bf16 v[96:99], v[164:167], a[196:199], v[96:99]
    ds_read_b128 a[244:247], v68 offset:4160
    buffer_load_dwordx4 v65, s[28:31], s45 offen  lds
    v_mfma_f32_16x16x32_bf16 v[100:103], v[180:183], a[196:199], v[100:103]
    ds_read_b128 a[248:251], v68 offset:1808
    v_mfma_f32_16x16x32_bf16 v[96:99], v[168:171], a[200:203], v[96:99]
    ds_read_b128 a[252:255], v68 offset:4176
    v_mfma_f32_16x16x32_bf16 v[100:103], v[184:187], a[200:203], v[100:103]
    ds_read_b64_tr_b16 a[68:69], v67 offset:8
    v_mfma_f32_16x16x32_bf16 v[96:99], v[172:175], a[204:207], v[96:99]
    ds_read_b64_tr_b16 a[70:71], v67 offset:2056
    v_mfma_f32_16x16x32_bf16 v[100:103], v[188:191], a[204:207], v[100:103]
    buffer_load_dwordx4 v65, s[32:35], s45 offen offset:1024  lds
    v_mfma_f32_16x16x32_bf16 v[96:99], v[144:147], a[208:211], v[96:99]
    ds_read_b64_tr_b16 a[72:73], v67 offset:1024
    v_mfma_f32_16x16x32_bf16 v[100:103], v[160:163], a[208:211], v[100:103]
    ds_read_b64_tr_b16 a[74:75], v67 offset:3072
    v_mfma_f32_16x16x32_bf16 v[96:99], v[148:151], a[212:215], v[96:99]
    ds_read_b64_tr_b16 a[76:77], v67 offset:1032
    v_mfma_f32_16x16x32_bf16 v[100:103], v[164:167], a[212:215], v[100:103]
    s_add_u32 m0, s44, 8192
    s_mov_b32 s45, 974848
    buffer_load_dwordx4 v65, s[28:31], s45 offen  lds
    v_mfma_f32_16x16x32_bf16 v[96:99], v[152:155], a[216:219], v[96:99]
    ds_read_b64_tr_b16 a[78:79], v67 offset:3080
    v_mfma_f32_16x16x32_bf16 v[100:103], v[168:171], a[216:219], v[100:103]
    ds_read_b64_tr_b16 a[80:81], v67 offset:16384
    v_mfma_f32_16x16x32_bf16 v[96:99], v[156:159], a[220:223], v[96:99]
    ds_read_b32 v112, v64 offset:1792
    ds_read_b32 v113, v64 offset:6528
    v_mfma_f32_16x16x32_bf16 v[100:103], v[172:175], a[220:223], v[100:103]
    ds_read_b64_tr_b16 a[82:83], v67 offset:18432
    s_waitcnt lgkmcnt(15)
    v_mfma_f32_16x16x32_bf16 v[96:99], v[128:131], a[224:227], v[96:99]
    buffer_load_dwordx4 v65, s[32:35], s45 offen offset:1024  lds
    v_mfma_f32_16x16x32_bf16 v[100:103], v[144:147], a[224:227], v[100:103]
    ds_read_b64_tr_b16 a[84:85], v67 offset:16392
    v_mfma_f32_16x16x32_bf16 v[96:99], v[132:135], a[228:231], v[96:99]
    ds_read_b64_tr_b16 a[86:87], v67 offset:18440
    v_mfma_f32_16x16x32_bf16 v[100:103], v[148:151], a[228:231], v[100:103]
    ds_read_b64_tr_b16 a[88:89], v67 offset:17408
    v_mfma_f32_16x16x32_bf16 v[96:99], v[136:139], a[232:235], v[96:99]
    s_add_u32 m0, s44, 16384
    s_waitcnt lgkmcnt(5)
    v_lshlrev_b32_e32 v116, 16, v112
    s_waitcnt lgkmcnt(4)
    v_lshlrev_b32_e32 v118, 16, v113
    v_and_b32_e64 v117, s71, v112
    v_mfma_f32_16x16x32_bf16 v[100:103], v[152:155], a[232:235], v[100:103]
    s_mov_b32 s45, 1032192
    v_and_b32_e64 v119, s71, v113
    v_mfma_f32_16x16x32_bf16 v[96:99], v[140:143], a[236:239], v[96:99]
    buffer_load_dwordx4 v65, s[28:31], s45 offen  lds
    v_mfma_f32_16x16x32_bf16 v[100:103], v[156:159], a[236:239], v[100:103]
    ds_read_b64_tr_b16 a[90:91], v67 offset:19456
    v_mfma_f32_16x16x32_bf16 v[100:103], v[128:131], a[240:243], v[100:103]
    ds_read_b64_tr_b16 a[92:93], v67 offset:17416
    v_mfma_f32_16x16x32_bf16 v[100:103], v[132:135], a[244:247], v[100:103]
    ds_read_b64_tr_b16 a[94:95], v67 offset:19464
    v_mfma_f32_16x16x32_bf16 v[100:103], v[136:139], a[248:251], v[100:103]
    v_mfma_f32_16x16x32_bf16 v[100:103], v[140:143], a[252:255], v[100:103]
    buffer_load_dwordx4 v65, s[32:35], s45 offen offset:1024  lds
    s_add_u32 m0, s44, 24576
    s_mov_b32 s45, 1089536
    buffer_load_dwordx4 v65, s[28:31], s45 offen  lds
    buffer_load_dwordx4 v65, s[32:35], s45 offen offset:1024  lds
    ds_write_b128 v69, v[96:99] offset:19712
    s_nop 1
    ds_write_b128 v69, v[100:103] offset:20992
    s_waitcnt vmcnt(8)
    s_waitcnt lgkmcnt(0)
    s_barrier
    ds_read_b64 v[104:105], v70 offset:19712
    ds_read_b64 v[106:107], v70 offset:22272
    ds_read_b64 v[108:109], v70 offset:24832
    ds_read_b64 v[110:111], v70 offset:27392
    s_add_u32 m0, s44, 32768
    s_mov_b32 s45, 1146880
    buffer_load_dwordx4 v65, s[28:31], s45 offen  lds
    buffer_load_dwordx4 v65, s[32:35], s45 offen offset:1024  lds
    s_add_u32 m0, s44, 40960
    s_mov_b32 s45, 1204224
    buffer_load_dwordx4 v65, s[28:31], s45 offen  lds
    buffer_load_dwordx4 v65, s[32:35], s45 offen offset:1024  lds
    s_nop 0
    s_waitcnt lgkmcnt(0)
    s_mov_b32 s64, 4096
    v_fma_f32 v104, v116, s48, v104
    v_fma_f32 v105, v117, s48, v105
    v_fma_f32 v108, v118, s49, v108
    v_fma_f32 v109, v119, s49, v109
    v_add_f32_e64 v104, v104, v106
    v_add_f32_e64 v105, v105, v107
    v_add_f32_e64 v108, v108, v110
    v_add_f32_e64 v109, v109, v111
    v_cvt_pk_bf16_f32 v122, v104, v108
    v_cvt_pk_bf16_f32 v123, v105, v109
    buffer_store_dwordx4 v[120:123], v71, s[24:27], s64 offen sc0 sc1
    s_add_u32 m0, s44, 49152
    s_mov_b32 s45, 1261568
    ds_read_b64_tr_b16 a[96:97], v67 offset:32768
    ds_read_b64_tr_b16 a[98:99], v67 offset:34816
    buffer_load_dwordx4 v65, s[28:31], s45 offen  lds
    ds_read_b64_tr_b16 a[100:101], v67 offset:32776
    ds_read_b64_tr_b16 a[102:103], v67 offset:34824
    buffer_load_dwordx4 v65, s[32:35], s45 offen offset:1024  lds
    ds_read_b64_tr_b16 a[104:105], v67 offset:33792
    ds_read_b64_tr_b16 a[106:107], v67 offset:35840
    s_add_u32 m0, s44, 57344
    s_mov_b32 s45, 1318912
    ds_read_b64_tr_b16 a[108:109], v67 offset:33800
    ds_read_b64_tr_b16 a[110:111], v67 offset:35848
    buffer_load_dwordx4 v65, s[28:31], s45 offen  lds
    ds_read_b64_tr_b16 a[112:113], v67 offset:49152
    ds_read_b64_tr_b16 a[114:115], v67 offset:51200
    buffer_load_dwordx4 v65, s[32:35], s45 offen offset:1024  lds
    ds_read_b64_tr_b16 a[116:117], v67 offset:49160
    ds_read_b64_tr_b16 a[118:119], v67 offset:51208
    s_add_u32 s55, s52, 32768
    s_nop 0
    s_waitcnt vmcnt(4)
    s_atomic_add s3, s[24:25], s55
    ds_read_b64_tr_b16 a[120:121], v67 offset:50176
    ds_read_b64_tr_b16 a[122:123], v67 offset:52224
    s_add_u32 m0, s44, 65536
    s_mov_b32 s45, 1376256
    ds_read_b64_tr_b16 a[124:125], v67 offset:50184
    ds_read_b64_tr_b16 a[126:127], v67 offset:52232
    buffer_load_dwordx4 v65, s[28:31], s45 offen  lds
    buffer_load_dwordx4 v65, s[32:35], s45 offen offset:1024  lds
    s_add_u32 m0, s44, 73728
    s_mov_b32 s45, 1433600
    buffer_load_dwordx4 v65, s[28:31], s45 offen  lds
    buffer_load_dwordx4 v65, s[32:35], s45 offen offset:1024  lds
    s_nop 0
    s_barrier
    s_add_u32 m0, s44, 81920
    s_mov_b32 s45, 1490944
    ds_read_b64_tr_b16 a[128:129], v66 offset:0
    ds_read_b64_tr_b16 a[130:131], v66 offset:2048
    ds_read_b64_tr_b16 a[132:133], v66 offset:8
    buffer_load_dwordx4 v65, s[28:31], s45 offen  lds
    ds_read_b64_tr_b16 a[134:135], v66 offset:2056
    ds_read_b64_tr_b16 a[136:137], v66 offset:1024
    ds_read_b64_tr_b16 a[138:139], v66 offset:3072
    buffer_load_dwordx4 v65, s[32:35], s45 offen offset:1024  lds
    ds_read_b64_tr_b16 a[140:141], v66 offset:1032
    ds_read_b64_tr_b16 a[142:143], v66 offset:3080
    ds_read_b64_tr_b16 a[144:145], v66 offset:16384
    s_add_u32 m0, s44, 90112
    s_mov_b32 s45, 1548288
    ds_read_b64_tr_b16 a[146:147], v66 offset:18432
    ds_read_b64_tr_b16 a[148:149], v66 offset:16392
    ds_read_b64_tr_b16 a[150:151], v66 offset:18440
    buffer_load_dwordx4 v65, s[28:31], s45 offen  lds
    ds_read_b64_tr_b16 a[152:153], v66 offset:17408
    ds_read_b64_tr_b16 a[154:155], v66 offset:19456
    ds_read_b64_tr_b16 a[156:157], v66 offset:17416
    buffer_load_dwordx4 v65, s[32:35], s45 offen offset:1024  lds
    ds_read_b64_tr_b16 a[158:159], v66 offset:19464
    ds_read_b64_tr_b16 a[160:161], v66 offset:32768
    ds_read_b64_tr_b16 a[162:163], v66 offset:34816
    ds_read_b64_tr_b16 a[164:165], v66 offset:32776
    ds_read_b64_tr_b16 a[166:167], v66 offset:34824
    ds_read_b64_tr_b16 a[168:169], v66 offset:33792
    ds_read_b64_tr_b16 a[170:171], v66 offset:35840
    ds_read_b64_tr_b16 a[172:173], v66 offset:33800
    ds_read_b64_tr_b16 a[174:175], v66 offset:35848
    s_waitcnt vmcnt(4)
    s_barrier
    ds_read_b64_tr_b16 a[176:177], v66 offset:49152
    ds_read_b64_tr_b16 a[178:179], v66 offset:51200
    ds_read_b64_tr_b16 a[180:181], v66 offset:49160
    ds_read_b64_tr_b16 a[182:183], v66 offset:51208
    ds_read_b64_tr_b16 a[184:185], v66 offset:50176
    ds_read_b64_tr_b16 a[186:187], v66 offset:52224
    ds_read_b64_tr_b16 a[188:189], v66 offset:50184
    ds_read_b64_tr_b16 a[190:191], v66 offset:52232
    ds_read_b64_tr_b16 a[192:193], v67 offset:0
    ds_read_b64_tr_b16 a[194:195], v67 offset:2048
    ds_read_b64_tr_b16 a[196:197], v67 offset:8
    ds_read_b64_tr_b16 a[198:199], v67 offset:2056
    ds_read_b64_tr_b16 a[200:201], v67 offset:1024
    ds_read_b64_tr_b16 a[202:203], v67 offset:3072
    ds_read_b64_tr_b16 a[204:205], v67 offset:1032
    ds_read_b64_tr_b16 a[206:207], v67 offset:3080
    s_waitcnt vmcnt(0)
    s_barrier
    ds_read_b64_tr_b16 a[208:209], v67 offset:16384
    ds_read_b64_tr_b16 a[210:211], v67 offset:18432
    ds_read_b64_tr_b16 a[212:213], v67 offset:16392
    ds_read_b64_tr_b16 a[214:215], v67 offset:18440
    ds_read_b64_tr_b16 a[216:217], v67 offset:17408
    ds_read_b64_tr_b16 a[218:219], v67 offset:19456
    ds_read_b64_tr_b16 a[220:221], v67 offset:17416
    ds_read_b64_tr_b16 a[222:223], v67 offset:19464
    ds_read_b32 v63, v14
    s_waitcnt lgkmcnt(1)
    s_barrier
    s_mov_b32 s81, 0
    s_atomic_add s81, s[24:25], s4 glc
    s_add_u32 m0, s9, 0
    s_nop 0
    s_add_u32 s20, s8, 0
    buffer_load_dwordx4 v20, s[36:39], s20 offen offset:0 lds
    buffer_load_dwordx4 v21, s[36:39], s20 offen offset:1024 lds
    buffer_load_dwordx4 v22, s[36:39], s20 offen offset:2048 lds
    buffer_load_dwordx4 v23, s[36:39], s20 offen offset:3072 lds
    s_add_u32 m0, s9, 4096
    s_add_u32 s20, s8, 28672
    buffer_load_dwordx4 v20, s[36:39], s20 offen offset:0 lds
    buffer_load_dwordx4 v21, s[36:39], s20 offen offset:1024 lds
    buffer_load_dwordx4 v22, s[36:39], s20 offen offset:2048 lds
    buffer_load_dwordx4 v23, s[36:39], s20 offen offset:3072 lds
    s_add_u32 m0, s9, 8192
    s_add_u32 s20, s8, 57344
    buffer_load_dwordx4 v20, s[36:39], s20 offen offset:0 lds
    buffer_load_dwordx4 v21, s[36:39], s20 offen offset:1024 lds
    buffer_load_dwordx4 v22, s[36:39], s20 offen offset:2048 lds
    buffer_load_dwordx4 v23, s[36:39], s20 offen offset:3072 lds
    s_add_u32 m0, s9, 12288
    s_add_u32 s20, s8, 86016
    buffer_load_dwordx4 v20, s[36:39], s20 offen offset:0 lds
    buffer_load_dwordx4 v21, s[36:39], s20 offen offset:1024 lds
    buffer_load_dwordx4 v22, s[36:39], s20 offen offset:2048 lds
    buffer_load_dwordx4 v23, s[36:39], s20 offen offset:3072 lds
    s_add_u32 m0, s9, 16384
    s_add_u32 s20, s8, 114688
    buffer_load_dwordx4 v20, s[36:39], s20 offen offset:0 lds
    buffer_load_dwordx4 v21, s[36:39], s20 offen offset:1024 lds
    buffer_load_dwordx4 v22, s[36:39], s20 offen offset:2048 lds
    buffer_load_dwordx4 v23, s[36:39], s20 offen offset:3072 lds
    s_cmp_eq_u32 s81, s76
    s_cbranch_scc0 L_retry_8
L_ok_7:
    s_add_u32 m0, s13, 0
    s_add_u32 s14, s5, 0
    buffer_load_dwordx4 v5, s[24:27], s14 offen offset:0 sc1 lds
    s_add_u32 m0, s13, 3968
    s_add_u32 s14, s5, 0
    buffer_load_dwordx4 v5, s[24:27], s14 offen offset:128 sc1 lds
    s_add_u32 m0, s13, 7936
    s_add_u32 s14, s5, 0
    buffer_load_dwordx4 v5, s[24:27], s14 offen offset:256 sc1 lds
    s_add_u32 m0, s13, 11904
    s_add_u32 s14, s5, 0
    buffer_load_dwordx4 v5, s[24:27], s14 offen offset:384 sc1 lds
    s_add_u32 m0, s13, 15872
    s_add_u32 s14, s5, 0
    buffer_load_dwordx4 v5, s[24:27], s14 offen offset:512 sc1 lds
    s_add_u32 m0, s13, 19840
    s_add_u32 s14, s5, 0
    buffer_load_dwordx4 v5, s[24:27], s14 offen offset:640 sc1 lds
    s_add_u32 m0, s13, 23808
    s_add_u32 s14, s5, 0
    buffer_load_dwordx4 v5, s[24:27], s14 offen offset:768 sc1 lds
    s_waitcnt vmcnt(4)
    s_waitcnt lgkmcnt(0)
    s_barrier
    ds_read_b128 v[40:43], v16 offset:0
    ds_read_b128 v[44:47], v16 offset:2048
    ds_read_b128 v[48:51], v17 offset:0
    ds_read_b128 v[52:55], v17 offset:2048
    s_waitcnt lgkmcnt(2)
    v_mfma_f32_16x16x32_bf16 v[80:83], a[0:3], v[44:47], 0
    ds_read_b128 v[56:59], v16 offset:4096
    v_mfma_f32_16x16x32_bf16 v[64:67], a[0:3], v[40:43], 0
    s_add_u32 s12, s4, 16384
    s_mov_b32 s78, 0
    s_atomic_add s78, s[24:25], s12 glc
    v_mfma_f32_16x16x32_bf16 v[84:87], a[4:7], v[44:47], 0
    ds_read_b128 v[60:63], v16 offset:6144
    v_mfma_f32_16x16x32_bf16 v[68:71], a[4:7], v[40:43], 0
    buffer_load_dwordx2 v[30:31], v7, s[24:27], s75 offen sc1
    v_mfma_f32_16x16x32_bf16 v[88:91], a[8:11], v[44:47], 0
    ds_read_b64_tr_b16 v[128:129], v24 offset:0
    v_mfma_f32_16x16x32_bf16 v[72:75], a[8:11], v[40:43], 0
    ds_read_b64_tr_b16 v[130:131], v24 offset:512
    v_mfma_f32_16x16x32_bf16 v[92:95], a[12:15], v[44:47], 0
    s_add_u32 m0, s9, 20480
    s_add_u32 s20, s8, 143360
    v_mfma_f32_16x16x32_bf16 v[76:79], a[12:15], v[40:43], 0
    buffer_load_dwordx4 v20, s[36:39], s20 offen offset:0 lds
    s_waitcnt lgkmcnt(4)
    v_mfma_f32_16x16x32_bf16 v[80:83], a[16:19], v[52:55], v[80:83]
    ds_read_b128 v[40:43], v17 offset:4096
    v_mfma_f32_16x16x32_bf16 v[64:67], a[16:19], v[48:51], v[64:67]
    ds_read_b64_tr_b16 v[132:133], v25 offset:0
    v_mfma_f32_16x16x32_bf16 v[84:87], a[20:23], v[52:55], v[84:87]
    ds_read_b128 v[44:47], v17 offset:6144
    v_mfma_f32_16x16x32_bf16 v[68:71], a[20:23], v[48:51], v[68:71]
    buffer_load_dwordx4 v21, s[36:39], s20 offen offset:1024 lds
    v_mfma_f32_16x16x32_bf16 v[88:91], a[24:27], v[52:55], v[88:91]
    ds_read_b64_tr_b16 v[134:135], v25 offset:512
    v_mfma_f32_16x16x32_bf16 v[72:75], a[24:27], v[48:51], v[72:75]
    ds_read_b64_tr_b16 v[136:137], v26 offset:0
    v_mfma_f32_16x16x32_bf16 v[92:95], a[28:31], v[52:55], v[92:95]
    ds_read_b64_tr_b16 v[138:139], v26 offset:512
    v_mfma_f32_16x16x32_bf16 v[76:79], a[28:31], v[48:51], v[76:79]
    buffer_load_dwordx4 v22, s[36:39], s20 offen offset:2048 lds
    s_waitcnt lgkmcnt(8)
    v_mfma_f32_16x16x32_bf16 v[80:83], a[32:35], v[60:63], v[80:83]
    ds_read_b128 v[48:51], v16 offset:8192
    v_mfma_f32_16x16x32_bf16 v[64:67], a[32:35], v[56:59], v[64:67]
    ds_read_b64_tr_b16 v[140:141], v27 offset:0
    v_mfma_f32_16x16x32_bf16 v[84:87], a[36:39], v[60:63], v[84:87]
    ds_read_b128 v[52:55], v16 offset:10240
    v_mfma_f32_16x16x32_bf16 v[68:71], a[36:39], v[56:59], v[68:71]
    buffer_load_dwordx4 v23, s[36:39], s20 offen offset:3072 lds
    v_mfma_f32_16x16x32_bf16 v[88:91], a[40:43], v[60:63], v[88:91]
    ds_read_b64_tr_b16 v[142:143], v27 offset:512
    v_mfma_f32_16x16x32_bf16 v[72:75], a[40:43], v[56:59], v[72:75]
    v_mfma_f32_16x16x32_bf16 v[92:95], a[44:47], v[60:63], v[92:95]
    ds_read_b32 v6, v14
    s_waitcnt lgkmcnt(1)
    s_add_u32 m0, s9, 0
    s_add_u32 s20, s8, 172032
    v_mfma_f32_16x16x32_bf16 v[76:79], a[44:47], v[56:59], v[76:79]
    buffer_load_dwordx4 v20, s[36:39], s20 offen offset:0 lds
    v_mfma_f32_16x16x32_bf16 v[80:83], a[48:51], v[44:47], v[80:83]
    ds_read_b128 v[56:59], v17 offset:8192
    v_mfma_f32_16x16x32_bf16 v[64:67], a[48:51], v[40:43], v[64:67]
    ds_read_b64_tr_b16 v[144:145], v24 offset:4096
    v_mfma_f32_16x16x32_bf16 v[84:87], a[52:55], v[44:47], v[84:87]
    ds_read_b128 v[60:63], v17 offset:10240
    v_mfma_f32_16x16x32_bf16 v[68:71], a[52:55], v[40:43], v[68:71]
    buffer_load_dwordx4 v21, s[36:39], s20 offen offset:1024 lds
    v_mfma_f32_16x16x32_bf16 v[88:91], a[56:59], v[44:47], v[88:91]
    s_mov_b32 s28, 0
    s_atomic_add s28, s[24:25], s12 glc
    v_mfma_f32_16x16x32_bf16 v[72:75], a[56:59], v[40:43], v[72:75]
    ds_read_b64_tr_b16 v[146:147], v24 offset:4608
    v_mfma_f32_16x16x32_bf16 v[92:95], a[60:63], v[44:47], v[92:95]
    s_waitcnt vmcnt(7)
    s_barrier
    v_mfma_f32_16x16x32_bf16 v[76:79], a[60:63], v[40:43], v[76:79]
    buffer_load_dwordx4 v22, s[36:39], s20 offen offset:2048 lds
    v_mfma_f32_16x16x32_bf16 v[80:83], a[64:67], v[52:55], v[80:83]
    ds_read_b128 v[40:43], v16 offset:12288
    v_mfma_f32_16x16x32_bf16 v[64:67], a[64:67], v[48:51], v[64:67]
    ds_read_b64_tr_b16 v[148:149], v25 offset:4096
    v_mfma_f32_16x16x32_bf16 v[84:87], a[68:71], v[52:55], v[84:87]
    ds_read_b128 v[44:47], v16 offset:14336
    v_mfma_f32_16x16x32_bf16 v[68:71], a[68:71], v[48:51], v[68:71]
    buffer_load_dwordx4 v23, s[36:39], s20 offen offset:3072 lds
    v_mfma_f32_16x16x32_bf16 v[88:91], a[72:75], v[52:55], v[88:91]
    ds_read_b64_tr_b16 v[150:151], v25 offset:4608
    v_mfma_f32_16x16x32_bf16 v[72:75], a[72:75], v[48:51], v[72:75]
    ds_read_b64_tr_b16 v[152:153], v26 offset:4096
    v_mfma_f32_16x16x32_bf16 v[92:95], a[76:79], v[52:55], v[92:95]
    ds_read_b64_tr_b16 v[154:155], v26 offset:4608
    v_mfma_f32_16x16x32_bf16 v[76:79], a[76:79], v[48:51], v[76:79]
    ds_read_b64_tr_b16 v[156:157], v27 offset:4096
    s_waitcnt lgkmcnt(8)
    v_mfma_f32_16x16x32_bf16 v[80:83], a[80:83], v[60:63], v[80:83]
    ds_read_b128 v[48:51], v17 offset:12288
    v_mfma_f32_16x16x32_bf16 v[64:67], a[80:83], v[56:59], v[64:67]
    ds_read_b64_tr_b16 v[158:159], v27 offset:4608
    v_mfma_f32_16x16x32_bf16 v[84:87], a[84:87], v[60:63], v[84:87]
    ds_read_b128 v[52:55], v17 offset:14336
    v_mfma_f32_16x16x32_bf16 v[68:71], a[84:87], v[56:59], v[68:71]
    v_mfma_f32_16x16x32_bf16 v[88:91], a[88:91], v[60:63], v[88:91]
    s_cmp_eq_u32 s78, s76
    s_cbranch_scc0 L_retry_11
L_ok_10:
    v_mfma_f32_16x16x32_bf16 v[72:75], a[88:91], v[56:59], v[72:75]
    s_add_u32 m0, s13, 36864
    s_add_u32 s14, s5, 458752
    v_mfma_f32_16x16x32_bf16 v[92:95], a[92:95], v[60:63], v[92:95]
    buffer_load_dwordx4 v5, s[24:27], s14 offen offset:0 sc1 lds
    v_mfma_f32_16x16x32_bf16 v[76:79], a[92:95], v[56:59], v[76:79]
    ds_read_b64_tr_b16 v[160:161], v24 offset:8192
    s_waitcnt lgkmcnt(8)
    v_mfma_f32_16x16x32_bf16 v[80:83], a[96:99], v[44:47], v[80:83]
    ds_read_b128 v[56:59], v16 offset:16384
    v_mfma_f32_16x16x32_bf16 v[64:67], a[96:99], v[40:43], v[64:67]
    s_add_u32 m0, s13, 40832
    s_add_u32 s14, s5, 458752
    v_mfma_f32_16x16x32_bf16 v[84:87], a[100:103], v[44:47], v[84:87]
    ds_read_b128 v[60:63], v16 offset:18432
    v_mfma_f32_16x16x32_bf16 v[68:71], a[100:103], v[40:43], v[68:71]
    buffer_load_dwordx4 v5, s[24:27], s14 offen offset:128 sc1 lds
    v_mfma_f32_16x16x32_bf16 v[88:91], a[104:107], v[44:47], v[88:91]
    ds_read_b64_tr_b16 v[162:163], v24 offset:8704
    v_mfma_f32_16x16x32_bf16 v[72:75], a[104:107], v[40:43], v[72:75]
    ds_read_b64_tr_b16 v[164:165], v25 offset:8192
    v_mfma_f32_16x16x32_bf16 v[92:95], a[108:111], v[44:47], v[92:95]
    s_add_u32 m0, s13, 44800
    s_add_u32 s14, s5, 458752
    v_mfma_f32_16x16x32_bf16 v[76:79], a[108:111], v[40:43], v[76:79]
    buffer_load_dwordx4 v5, s[24:27], s14 offen offset:256 sc1 lds
    s_waitcnt lgkmcnt(5)
    v_mfma_f32_16x16x32_bf16 v[80:83], a[112:115], v[52:55], v[80:83]
    ds_read_b128 v[40:43], v17 offset:16384
    v_mfma_f32_16x16x32_bf16 v[64:67], a[112:115], v[48:51], v[64:67]
    ds_read_b64_tr_b16 v[166:167], v25 offset:8704
    v_mfma_f32_16x16x32_bf16 v[84:87], a[116:119], v[52:55], v[84:87]
    ds_read_b128 v[44:47], v17 offset:18432
    v_mfma_f32_16x16x32_bf16 v[68:71], a[116:119], v[48:51], v[68:71]
    s_add_u32 m0, s13, 48768
    s_add_u32 s14, s5, 458752
    v_mfma_f32_16x16x32_bf16 v[88:91], a[120:123], v[52:55], v[88:91]
    buffer_load_dwordx4 v5, s[24:27], s14 offen offset:384 sc1 lds
    v_mfma_f32_16x16x32_bf16 v[72:75], a[120:123], v[48:51], v[72:75]
    s_waitcnt vmcnt(12)
    v_lshlrev_b32 v28, 16, v30
    v_and_b32 v29, s71, v30
    v_mfma_f32_16x16x32_bf16 v[92:95], a[124:127], v[52:55], v[92:95]
    v_lshlrev_b32 v30, 16, v31
    v_and_b32 v31, s71, v31
    v_mfma_f32_16x16x32_bf16 v[76:79], a[124:127], v[48:51], v[76:79]
    s_add_u32 m0, s13, 52736
    s_add_u32 s14, s5, 458752
    s_waitcnt lgkmcnt(5)
    v_mfma_f32_16x16x32_bf16 v[80:83], a[128:131], v[60:63], v[80:83]
    ds_read_b128 v[48:51], v16 offset:20480
    v_mfma_f32_16x16x32_bf16 v[64:67], a[128:131], v[56:59], v[64:67]
    buffer_load_dwordx4 v5, s[24:27], s14 offen offset:512 sc1 lds
    v_mfma_f32_16x16x32_bf16 v[84:87], a[132:135], v[60:63], v[84:87]
    ds_read_b128 v[52:55], v16 offset:22528
    v_mfma_f32_16x16x32_bf16 v[68:71], a[132:135], v[56:59], v[68:71]
    ds_read_b64_tr_b16 v[168:169], v26 offset:8192
    v_mfma_f32_16x16x32_bf16 v[88:91], a[136:139], v[60:63], v[88:91]
    s_add_u32 m0, s13, 56704
    s_add_u32 s14, s5, 458752
    v_mfma_f32_16x16x32_bf16 v[72:75], a[136:139], v[56:59], v[72:75]
    buffer_load_dwordx4 v5, s[24:27], s14 offen offset:640 sc1 lds
    v_mfma_f32_16x16x32_bf16 v[92:95], a[140:143], v[60:63], v[92:95]
    ds_read_b64_tr_b16 v[170:171], v26 offset:8704
    v_mfma_f32_16x16x32_bf16 v[76:79], a[140:143], v[56:59], v[76:79]
    ds_read_b64_tr_b16 v[172:173], v27 offset:8192
    s_waitcnt lgkmcnt(5)
    v_mfma_f32_16x16x32_bf16 v[80:83], a[144:147], v[44:47], v[80:83]
    ds_read_b128 v[56:59], v17 offset:20480
    v_mfma_f32_16x16x32_bf16 v[64:67], a[144:147], v[40:43], v[64:67]
    s_add_u32 m0, s13, 60672
    s_add_u32 s14, s5, 458752
    v_mfma_f32_16x16x32_bf16 v[84:87], a[148:151], v[44:47], v[84:87]
    ds_read_b128 v[60:63], v17 offset:22528
    v_mfma_f32_16x16x32_bf16 v[68:71], a[148:151], v[40:43], v[68:71]
    buffer_load_dwordx4 v5, s[24:27], s14 offen offset:768 sc1 lds
    v_mfma_f32_16x16x32_bf16 v[88:91], a[152:155], v[44:47], v[88:91]
    ds_read_b64_tr_b16 v[174:175], v27 offset:8704
    v_mfma_f32_16x16x32_bf16 v[72:75], a[152:155], v[40:43], v[72:75]
    ds_read_b64_tr_b16 v[176:177], v24 offset:12288
    v_mfma_f32_16x16x32_bf16 v[92:95], a[156:159], v[44:47], v[92:95]
    s_add_u32 m0, s9, 4096
    s_add_u32 s20, s8, 200704
    v_mfma_f32_16x16x32_bf16 v[76:79], a[156:159], v[40:43], v[76:79]
    buffer_load_dwordx4 v20, s[36:39], s20 offen offset:0 lds
    s_waitcnt lgkmcnt(7)
    v_mfma_f32_16x16x32_bf16 v[80:83], a[160:163], v[52:55], v[80:83]
    ds_read_b128 v[40:43], v16 offset:24576
    v_mfma_f32_16x16x32_bf16 v[64:67], a[160:163], v[48:51], v[64:67]
    ds_read_b64_tr_b16 v[178:179], v24 offset:12800
    v_mfma_f32_16x16x32_bf16 v[84:87], a[164:167], v[52:55], v[84:87]
    ds_read_b128 v[44:47], v16 offset:26624
    v_mfma_f32_16x16x32_bf16 v[68:71], a[164:167], v[48:51], v[68:71]
    buffer_load_dwordx4 v21, s[36:39], s20 offen offset:1024 lds
    v_mfma_f32_16x16x32_bf16 v[88:91], a[168:171], v[52:55], v[88:91]
    ds_read_b64_tr_b16 v[180:181], v25 offset:12288
    v_mfma_f32_16x16x32_bf16 v[72:75], a[168:171], v[48:51], v[72:75]
    ds_read_b64_tr_b16 v[182:183], v25 offset:12800
    v_mfma_f32_16x16x32_bf16 v[92:95], a[172:175], v[52:55], v[92:95]
    ds_read_b64_tr_b16 v[184:185], v26 offset:12288
    v_mfma_f32_16x16x32_bf16 v[76:79], a[172:175], v[48:51], v[76:79]
    buffer_load_dwordx4 v22, s[36:39], s20 offen offset:2048 lds
    s_waitcnt lgkmcnt(8)
    v_mfma_f32_16x16x32_bf16 v[80:83], a[176:179], v[60:63], v[80:83]
    ds_read_b128 v[48:51], v17 offset:24576
    v_mfma_f32_16x16x32_bf16 v[64:67], a[176:179], v[56:59], v[64:67]
    ds_read_b64_tr_b16 v[186:187], v26 offset:12800
    v_mfma_f32_16x16x32_bf16 v[84:87], a[180:183], v[60:63], v[84:87]
    ds_read_b128 v[52:55], v17 offset:26624
    v_mfma_f32_16x16x32_bf16 v[68:71], a[180:183], v[56:59], v[68:71]
    buffer_load_dwordx4 v23, s[36:39], s20 offen offset:3072 lds
    v_mfma_f32_16x16x32_bf16 v[88:91], a[184:187], v[60:63], v[88:91]
    ds_read_b64_tr_b16 v[188:189], v27 offset:12288
    v_mfma_f32_16x16x32_bf16 v[72:75], a[184:187], v[56:59], v[72:75]
    ds_read_b64_tr_b16 v[190:191], v27 offset:12800
    v_mfma_f32_16x16x32_bf16 v[92:95], a[188:191], v[60:63], v[92:95]
    s_waitcnt lgkmcnt(12)
    s_add_u32 m0, s9, 8192
    s_add_u32 s20, s8, 229376
    v_mfma_f32_16x16x32_bf16 v[76:79], a[188:191], v[56:59], v[76:79]
    buffer_load_dwordx4 v20, s[36:39], s20 offen offset:0 lds
    s_waitcnt lgkmcnt(8)
    v_mfma_f32_16x16x32_bf16 v[80:83], a[192:195], v[44:47], v[80:83]
    ds_read_b64_tr_b16 v[192:193], v24 offset:16384
    v_mfma_f32_16x16x32_bf16 v[64:67], a[192:195], v[40:43], v[64:67]
    ds_read_b64_tr_b16 v[194:195], v24 offset:16896
    v_mfma_f32_16x16x32_bf16 v[84:87], a[196:199], v[44:47], v[84:87]
    ds_read_b64_tr_b16 v[196:197], v25 offset:16384
    v_mfma_f32_16x16x32_bf16 v[68:71], a[196:199], v[40:43], v[68:71]
    buffer_load_dwordx4 v21, s[36:39], s20 offen offset:1024 lds
    v_mfma_f32_16x16x32_bf16 v[88:91], a[200:203], v[44:47], v[88:91]
    s_waitcnt vmcnt(10)
    s_waitcnt lgkmcnt(0)
    s_barrier
    v_mfma_f32_16x16x32_bf16 v[72:75], a[200:203], v[40:43], v[72:75]
    ds_read_b128 v[56:59], v16 offset:36864
    v_mfma_f32_16x16x32_bf16 v[92:95], a[204:207], v[44:47], v[92:95]
    ds_read_b128 v[60:63], v16 offset:38912
    v_mfma_f32_16x16x32_bf16 v[76:79], a[204:207], v[40:43], v[76:79]
    buffer_load_dwordx4 v22, s[36:39], s20 offen offset:2048 lds
    v_mfma_f32_16x16x32_bf16 v[80:83], a[208:211], v[52:55], v[80:83]
    ds_read_b128 v[40:43], v17 offset:36864
    v_mfma_f32_16x16x32_bf16 v[64:67], a[208:211], v[48:51], v[64:67]
    ds_read_b64_tr_b16 v[198:199], v25 offset:16896
    v_mfma_f32_16x16x32_bf16 v[84:87], a[212:215], v[52:55], v[84:87]
    ds_read_b128 v[44:47], v17 offset:38912
    v_mfma_f32_16x16x32_bf16 v[68:71], a[212:215], v[48:51], v[68:71]
    s_add_u32 s12, s4, 32768
    s_mov_b32 s78, 0
    s_atomic_add s78, s[24:25], s12 glc
    v_mfma_f32_16x16x32_bf16 v[88:91], a[216:219], v[52:55], v[88:91]
    buffer_load_dwordx4 v23, s[36:39], s20 offen offset:3072 lds
    v_mfma_f32_16x16x32_bf16 v[72:75], a[216:219], v[48:51], v[72:75]
    ds_read_b64_tr_b16 v[200:201], v26 offset:16384
    v_mfma_f32_16x16x32_bf16 v[92:95], a[220:223], v[52:55], v[92:95]
    ds_read_b64_tr_b16 v[202:203], v26 offset:16896
    v_mfma_f32_16x16x32_bf16 v[76:79], a[220:223], v[48:51], v[76:79]
    s_add_u32 m0, s9, 12288
    s_add_u32 s20, s8, 258048
    s_waitcnt lgkmcnt(5)
    v_mfma_f32_16x16x32_bf16 v[112:115], a[0:3], v[60:63], 0
    ds_read_b128 v[48:51], v16 offset:40960
    v_mfma_f32_16x16x32_bf16 v[96:99], a[0:3], v[56:59], 0
    buffer_load_dwordx4 v20, s[36:39], s20 offen offset:0 lds
    v_mfma_f32_16x16x32_bf16 v[116:119], a[4:7], v[60:63], 0
    ds_read_b128 v[52:55], v16 offset:43008
    v_mfma_f32_16x16x32_bf16 v[100:103], a[4:7], v[56:59], 0
    ds_read_b64_tr_b16 v[204:205], v27 offset:16384
    v_mfma_f32_16x16x32_bf16 v[120:123], a[8:11], v[60:63], 0
    s_add_u32 s21, s6, 0
    v_mul_f32_e64 v64, v64, v72
    v_mul_f32_e64 v65, v65, v73
    v_mfma_f32_16x16x32_bf16 v[104:107], a[8:11], v[56:59], 0
    buffer_load_dwordx4 v21, s[36:39], s20 offen offset:1024 lds
    v_mfma_f32_16x16x32_bf16 v[124:127], a[12:15], v[60:63], 0
    v_mul_f32_e64 v66, v66, v74
    v_mul_f32_e64 v67, v67, v75
    v_mfma_f32_16x16x32_bf16 v[108:111], a[12:15], v[56:59], 0
    v_mul_f32_e64 v68, v68, v76
    v_mul_f32_e64 v69, v69, v77
    s_waitcnt lgkmcnt(5)
    v_mfma_f32_16x16x32_bf16 v[112:115], a[16:19], v[44:47], v[112:115]
    ds_read_b128 v[56:59], v17 offset:40960
    v_mul_f32_e32 v70, v70, v78
    v_mfma_f32_16x16x32_bf16 v[96:99], a[16:19], v[40:43], v[96:99]
    buffer_load_dwordx4 v22, s[36:39], s20 offen offset:2048 lds
    v_mfma_f32_16x16x32_bf16 v[116:119], a[20:23], v[44:47], v[116:119]
    ds_read_b128 v[60:63], v17 offset:43008
    v_mul_f32_e64 v71, v71, v79
    v_mfma_f32_16x16x32_bf16 v[100:103], a[20:23], v[40:43], v[100:103]
    v_cvt_pk_bf16_f32 v32, v64, v65
    v_cvt_pk_bf16_f32 v33, v66, v67
    v_mfma_f32_16x16x32_bf16 v[120:123], a[24:27], v[44:47], v[120:123]
    v_cvt_pk_bf16_f32 v34, v68, v69
    v_cvt_pk_bf16_f32 v35, v70, v71
    v_mfma_f32_16x16x32_bf16 v[104:107], a[24:27], v[40:43], v[104:107]
    buffer_load_dwordx4 v23, s[36:39], s20 offen offset:3072 lds
    v_mfma_f32_16x16x32_bf16 v[124:127], a[28:31], v[44:47], v[124:127]
    v_mul_f32_e64 v80, v80, v88
    v_mul_f32_e64 v81, v81, v89
    v_mfma_f32_16x16x32_bf16 v[108:111], a[28:31], v[40:43], v[108:111]
    v_mul_f32_e64 v82, v82, v90
    v_mul_f32_e64 v83, v83, v91
    s_waitcnt lgkmcnt(3)
    v_mfma_f32_16x16x32_bf16 v[112:115], a[32:35], v[52:55], v[112:115]
    ds_read_b128 v[40:43], v16 offset:45056
    v_mul_f32_e32 v84, v84, v92
    v_mfma_f32_16x16x32_bf16 v[96:99], a[32:35], v[48:51], v[96:99]
    v_mul_f32_e64 v85, v85, v93
    v_mul_f32_e64 v86, v86, v94
    v_mfma_f32_16x16x32_bf16 v[116:119], a[36:39], v[52:55], v[116:119]
    ds_read_b128 v[44:47], v16 offset:47104
    v_mul_f32_e64 v87, v87, v95
    v_mfma_f32_16x16x32_bf16 v[100:103], a[36:39], v[48:51], v[100:103]
    v_cvt_pk_bf16_f32 v36, v80, v81
    v_cvt_pk_bf16_f32 v37, v82, v83
    v_mfma_f32_16x16x32_bf16 v[120:123], a[40:43], v[52:55], v[120:123]
    v_cvt_pk_bf16_f32 v38, v84, v85
    v_cvt_pk_bf16_f32 v39, v86, v87
    v_mfma_f32_16x16x32_bf16 v[104:107], a[40:43], v[48:51], v[104:107]
    buffer_store_dwordx4 v[32:35], v12, s[24:27], s21 offen sc0 sc1
    v_mfma_f32_16x16x32_bf16 v[124:127], a[44:47], v[52:55], v[124:127]
    s_mov_b32 s29, 0
    s_atomic_add s29, s[24:25], s12 glc
    v_mfma_f32_16x16x32_bf16 v[108:111], a[44:47], v[48:51], v[108:111]
    ds_read_b64_tr_b16 v[206:207], v27 offset:16896
    s_waitcnt lgkmcnt(3)
    v_mfma_f32_16x16x32_bf16 v[112:115], a[48:51], v[60:63], v[112:115]
    ds_read_b128 v[48:51], v17 offset:45056
    v_mfma_f32_16x16x32_bf16 v[96:99], a[48:51], v[56:59], v[96:99]
    buffer_store_dwordx4 v[36:39], v18, s[24:27], s21 offen sc0 sc1
    v_mfma_f32_16x16x32_bf16 v[116:119], a[52:55], v[60:63], v[116:119]
    ds_read_b128 v[52:55], v17 offset:47104
    v_mfma_f32_16x16x32_bf16 v[100:103], a[52:55], v[56:59], v[100:103]
    ds_read_b64_tr_b16 v[208:209], v24 offset:20480
    v_mfma_f32_16x16x32_bf16 v[120:123], a[56:59], v[60:63], v[120:123]
    ds_read_b64_tr_b16 v[210:211], v24 offset:20992
    v_mfma_f32_16x16x32_bf16 v[104:107], a[56:59], v[56:59], v[104:107]
    ds_read_b64_tr_b16 v[212:213], v25 offset:20480
    v_mfma_f32_16x16x32_bf16 v[124:127], a[60:63], v[60:63], v[124:127]
    s_waitcnt vmcnt(14)
    s_barrier
    v_mfma_f32_16x16x32_bf16 v[108:111], a[60:63], v[56:59], v[108:111]
    ds_read_b64_tr_b16 v[214:215], v25 offset:20992
    s_waitcnt lgkmcnt(7)
    v_mfma_f32_16x16x32_bf16 v[112:115], a[64:67], v[44:47], v[112:115]
    ds_read_b128 v[56:59], v16 offset:49152
    v_mfma_f32_16x16x32_bf16 v[96:99], a[64:67], v[40:43], v[96:99]
    ds_read_b64_tr_b16 v[216:217], v26 offset:20480
    v_mfma_f32_16x16x32_bf16 v[116:119], a[68:71], v[44:47], v[116:119]
    ds_read_b128 v[60:63], v16 offset:51200
    v_mfma_f32_16x16x32_bf16 v[100:103], a[68:71], v[40:43], v[100:103]
    ds_read_b64_tr_b16 v[218:219], v26 offset:20992
    v_mfma_f32_16x16x32_bf16 v[120:123], a[72:75], v[44:47], v[120:123]
    ds_read_b64_tr_b16 v[220:221], v27 offset:20480
    v_mfma_f32_16x16x32_bf16 v[104:107], a[72:75], v[40:43], v[104:107]
    ds_read_b64_tr_b16 v[222:223], v27 offset:20992
    v_mfma_f32_16x16x32_bf16 v[124:127], a[76:79], v[44:47], v[124:127]
    s_cmp_eq_u32 s78, s76
    s_cbranch_scc0 L_retry_14
L_ok_13:
    v_mfma_f32_16x16x32_bf16 v[108:111], a[76:79], v[40:43], v[108:111]
    s_add_u32 m0, s13, 0
    s_add_u32 s14, s5, 917504
    s_waitcnt lgkmcnt(10)
    v_mfma_f32_16x16x32_bf16 v[112:115], a[80:83], v[52:55], v[112:115]
    ds_read_b128 v[40:43], v17 offset:49152
    v_mfma_f32_16x16x32_bf16 v[96:99], a[80:83], v[48:51], v[96:99]
    buffer_load_dwordx4 v5, s[24:27], s14 offen offset:0 sc1 lds
    v_mfma_f32_16x16x32_bf16 v[116:119], a[84:87], v[52:55], v[116:119]
    ds_read_b128 v[44:47], v17 offset:51200
    v_mfma_f32_16x16x32_bf16 v[100:103], a[84:87], v[48:51], v[100:103]
    ds_read_b64_tr_b16 v[224:225], v24 offset:0
    v_mfma_f32_16x16x32_bf16 v[120:123], a[88:91], v[52:55], v[120:123]
    s_add_u32 m0, s13, 3968
    s_add_u32 s14, s5, 917504
    v_mfma_f32_16x16x32_bf16 v[104:107], a[88:91], v[48:51], v[104:107]
    buffer_load_dwordx4 v5, s[24:27], s14 offen offset:128 sc1 lds
    v_mfma_f32_16x16x32_bf16 v[124:127], a[92:95], v[52:55], v[124:127]
    ds_read_b64_tr_b16 v[226:227], v24 offset:512
    v_mfma_f32_16x16x32_bf16 v[108:111], a[92:95], v[48:51], v[108:111]
    ds_read_b64_tr_b16 v[228:229], v25 offset:0
    s_waitcnt lgkmcnt(8)
    v_mfma_f32_16x16x32_bf16 v[112:115], a[96:99], v[60:63], v[112:115]
    ds_read_b128 v[48:51], v16 offset:53248
    v_mfma_f32_16x16x32_bf16 v[96:99], a[96:99], v[56:59], v[96:99]
    s_add_u32 m0, s13, 7936
    s_add_u32 s14, s5, 917504
    v_mfma_f32_16x16x32_bf16 v[116:119], a[100:103], v[60:63], v[116:119]
    ds_read_b128 v[52:55], v16 offset:55296
    v_mfma_f32_16x16x32_bf16 v[100:103], a[100:103], v[56:59], v[100:103]
    buffer_load_dwordx4 v5, s[24:27], s14 offen offset:256 sc1 lds
    v_mfma_f32_16x16x32_bf16 v[120:123], a[104:107], v[60:63], v[120:123]
    ds_read_b64_tr_b16 v[230:231], v25 offset:512
    v_mfma_f32_16x16x32_bf16 v[104:107], a[104:107], v[56:59], v[104:107]
    ds_read_b64_tr_b16 v[232:233], v26 offset:0
    v_mfma_f32_16x16x32_bf16 v[124:127], a[108:111], v[60:63], v[124:127]
    s_add_u32 m0, s13, 11904
    s_add_u32 s14, s5, 917504
    v_mfma_f32_16x16x32_bf16 v[108:111], a[108:111], v[56:59], v[108:111]
    buffer_load_dwordx4 v5, s[24:27], s14 offen offset:384 sc1 lds
    s_waitcnt lgkmcnt(7)
    v_mfma_f32_16x16x32_bf16 v[112:115], a[112:115], v[44:47], v[112:115]
    ds_read_b128 v[56:59], v17 offset:53248
    v_mfma_f32_16x16x32_bf16 v[96:99], a[112:115], v[40:43], v[96:99]
    ds_read_b64_tr_b16 v[234:235], v26 offset:512
    v_mfma_f32_16x16x32_bf16 v[116:119], a[116:119], v[44:47], v[116:119]
    ds_read_b128 v[60:63], v17 offset:55296
    v_mfma_f32_16x16x32_bf16 v[100:103], a[116:119], v[40:43], v[100:103]
    s_add_u32 m0, s13, 15872
    s_add_u32 s14, s5, 917504
    v_mfma_f32_16x16x32_bf16 v[120:123], a[120:123], v[44:47], v[120:123]
    buffer_load_dwordx4 v5, s[24:27], s14 offen offset:512 sc1 lds
    v_mfma_f32_16x16x32_bf16 v[104:107], a[120:123], v[40:43], v[104:107]
    ds_read_b64_tr_b16 v[236:237], v27 offset:0
    v_mfma_f32_16x16x32_bf16 v[124:127], a[124:127], v[44:47], v[124:127]
    ds_read_b64_tr_b16 v[238:239], v27 offset:512
    v_mfma_f32_16x16x32_bf16 v[108:111], a[124:127], v[40:43], v[108:111]
    s_add_u32 m0, s13, 19840
    s_add_u32 s14, s5, 917504
    s_waitcnt lgkmcnt(7)
    v_mfma_f32_16x16x32_bf16 v[112:115], a[128:131], v[52:55], v[112:115]
    ds_read_b128 v[40:43], v16 offset:57344
    v_mfma_f32_16x16x32_bf16 v[96:99], a[128:131], v[48:51], v[96:99]
    buffer_load_dwordx4 v5, s[24:27], s14 offen offset:640 sc1 lds
    v_mfma_f32_16x16x32_bf16 v[116:119], a[132:135], v[52:55], v[116:119]
    ds_read_b128 v[44:47], v16 offset:59392
    v_mfma_f32_16x16x32_bf16 v[100:103], a[132:135], v[48:51], v[100:103]
    s_waitcnt vmcnt(16)
    ds_read_b64_tr_b16 v[240:241], v24 offset:4096
    v_mfma_f32_16x16x32_bf16 v[120:123], a[136:139], v[52:55], v[120:123]
    s_add_u32 m0, s13, 23808
    s_add_u32 s14, s5, 917504
    v_mfma_f32_16x16x32_bf16 v[104:107], a[136:139], v[48:51], v[104:107]
    buffer_load_dwordx4 v5, s[24:27], s14 offen offset:768 sc1 lds
    v_mfma_f32_16x16x32_bf16 v[124:127], a[140:143], v[52:55], v[124:127]
    ds_read_b64_tr_b16 v[242:243], v24 offset:4608
    v_mfma_f32_16x16x32_bf16 v[108:111], a[140:143], v[48:51], v[108:111]
    ds_read_b64_tr_b16 v[244:245], v25 offset:4096
    s_waitcnt lgkmcnt(7)
    v_mfma_f32_16x16x32_bf16 v[112:115], a[144:147], v[60:63], v[112:115]
    ds_read_b128 v[48:51], v17 offset:57344
    v_mfma_f32_16x16x32_bf16 v[96:99], a[144:147], v[56:59], v[96:99]
    s_add_u32 m0, s9, 16384
    s_add_u32 s20, s8, 286720
    v_mfma_f32_16x16x32_bf16 v[116:119], a[148:151], v[60:63], v[116:119]
    ds_read_b128 v[52:55], v17 offset:59392
    v_mfma_f32_16x16x32_bf16 v[100:103], a[148:151], v[56:59], v[100:103]
    s_add_u32 s50, s7, 0
    s_waitcnt vmcnt(7)
    s_atomic_add s3, s[24:25], s50
    v_mfma_f32_16x16x32_bf16 v[120:123], a[152:155], v[60:63], v[120:123]
    buffer_load_dwordx4 v20, s[36:39], s20 offen offset:0 lds
    v_mfma_f32_16x16x32_bf16 v[104:107], a[152:155], v[56:59], v[104:107]
    ds_read_b64_tr_b16 v[246:247], v25 offset:4608
    v_mfma_f32_16x16x32_bf16 v[124:127], a[156:159], v[60:63], v[124:127]
    ds_read_b64_tr_b16 v[248:249], v26 offset:4096
    v_mfma_f32_16x16x32_bf16 v[108:111], a[156:159], v[56:59], v[108:111]
    ds_read_b64_tr_b16 v[250:251], v26 offset:4608
    s_waitcnt lgkmcnt(8)
    v_mfma_f32_16x16x32_bf16 v[112:115], a[160:163], v[44:47], v[112:115]
    ds_read_b128 v[56:59], v16 offset:61440
    v_mfma_f32_16x16x32_bf16 v[96:99], a[160:163], v[40:43], v[96:99]
    buffer_load_dwordx4 v21, s[36:39], s20 offen offset:1024 lds
    v_mfma_f32_16x16x32_bf16 v[116:119], a[164:167], v[44:47], v[116:119]
    ds_read_b128 v[60:63], v16 offset:63488
    v_mfma_f32_16x16x32_bf16 v[100:103], a[164:167], v[40:43], v[100:103]
    ds_read_b64_tr_b16 v[252:253], v27 offset:4096
    v_mfma_f32_16x16x32_bf16 v[120:123], a[168:171], v[44:47], v[120:123]
    ds_read_b64_tr_b16 v[254:255], v27 offset:4608
    v_mfma_f32_16x16x32_bf16 v[104:107], a[168:171], v[40:43], v[104:107]
    buffer_load_dwordx4 v22, s[36:39], s20 offen offset:2048 lds
    v_mfma_f32_16x16x32_bf16 v[124:127], a[172:175], v[44:47], v[124:127]
    v_mfma_f32_16x16x32_bf16 v[108:111], a[172:175], v[40:43], v[108:111]
    s_waitcnt lgkmcnt(7)
    v_mfma_f32_16x16x32_bf16 v[112:115], a[176:179], v[52:55], v[112:115]
    ds_read_b128 v[40:43], v17 offset:61440
    v_mfma_f32_16x16x32_bf16 v[96:99], a[176:179], v[48:51], v[96:99]
    buffer_load_dwordx4 v23, s[36:39], s20 offen offset:3072 lds
    v_mfma_f32_16x16x32_bf16 v[116:119], a[180:183], v[52:55], v[116:119]
    ds_read_b128 v[44:47], v17 offset:63488
    v_mfma_f32_16x16x32_bf16 v[100:103], a[180:183], v[48:51], v[100:103]
    v_mfma_f32_16x16x32_bf16 v[120:123], a[184:187], v[52:55], v[120:123]
    s_add_u32 m0, s9, 20480
    s_add_u32 s20, s8, 315392
    v_mfma_f32_16x16x32_bf16 v[104:107], a[184:187], v[48:51], v[104:107]
    buffer_load_dwordx4 v20, s[36:39], s20 offen offset:0 lds
    v_mfma_f32_16x16x32_bf16 v[124:127], a[188:191], v[52:55], v[124:127]
    v_mfma_f32_16x16x32_bf16 v[108:111], a[188:191], v[48:51], v[108:111]
    s_waitcnt lgkmcnt(4)
    v_mfma_f32_16x16x32_bf16 v[112:115], a[192:195], v[60:63], v[112:115]
    v_mfma_f32_16x16x32_bf16 v[96:99], a[192:195], v[56:59], v[96:99]
    buffer_load_dwordx4 v21, s[36:39], s20 offen offset:1024 lds
    v_mfma_f32_16x16x32_bf16 v[116:119], a[196:199], v[60:63], v[116:119]
    v_mfma_f32_16x16x32_bf16 v[100:103], a[196:199], v[56:59], v[100:103]
    v_mfma_f32_16x16x32_bf16 v[120:123], a[200:203], v[60:63], v[120:123]
    s_waitcnt vmcnt(10)
    ds_read_b32 v6, v14
    s_waitcnt lgkmcnt(1)
    s_barrier
    v_mfma_f32_16x16x32_bf16 v[104:107], a[200:203], v[56:59], v[104:107]
    ds_read_b128 v[48:51], v16 offset:0
    v_mfma_f32_16x16x32_bf16 v[124:127], a[204:207], v[60:63], v[124:127]
    ds_read_b128 v[52:55], v16 offset:2048
    v_mfma_f32_16x16x32_bf16 v[108:111], a[204:207], v[56:59], v[108:111]
    buffer_load_dwordx4 v22, s[36:39], s20 offen offset:2048 lds
    v_mfma_f32_16x16x32_bf16 v[112:115], a[208:211], v[44:47], v[112:115]
    ds_read_b128 v[56:59], v17 offset:0
    v_mfma_f32_16x16x32_bf16 v[96:99], a[208:211], v[40:43], v[96:99]
    v_mfma_f32_16x16x32_bf16 v[116:119], a[212:215], v[44:47], v[116:119]
    ds_read_b128 v[60:63], v17 offset:2048
    v_mfma_f32_16x16x32_bf16 v[100:103], a[212:215], v[40:43], v[100:103]
    buffer_load_dwordx4 v23, s[36:39], s20 offen offset:3072 lds
    v_mfma_f32_16x16x32_bf16 v[120:123], a[216:219], v[44:47], v[120:123]
    v_mfma_f32_16x16x32_bf16 v[104:107], a[216:219], v[40:43], v[104:107]
    v_mfma_f32_16x16x32_bf16 v[124:127], a[220:223], v[44:47], v[124:127]
    s_add_u32 m0, s9, 0
    s_add_u32 s20, s8, 344064
    v_mfma_f32_16x16x32_bf16 v[108:111], a[220:223], v[40:43], v[108:111]
    buffer_load_dwordx4 v20, s[36:39], s20 offen offset:0 lds
    s_waitcnt lgkmcnt(2)
    v_mfma_f32_16x16x32_bf16 v[80:83], a[0:3], v[52:55], 0
    ds_read_b128 v[40:43], v16 offset:4096
    v_mfma_f32_16x16x32_bf16 v[64:67], a[0:3], v[48:51], 0
    s_add_u32 s12, s4, 49152
    s_mov_b32 s78, 0
    s_atomic_add s78, s[24:25], s12 glc
    v_mfma_f32_16x16x32_bf16 v[84:87], a[4:7], v[52:55], 0
    ds_read_b128 v[44:47], v16 offset:6144
    v_mfma_f32_16x16x32_bf16 v[68:71], a[4:7], v[48:51], 0
    buffer_load_dwordx4 v21, s[36:39], s20 offen offset:1024 lds
    v_mfma_f32_16x16x32_bf16 v[88:91], a[8:11], v[52:55], 0
    s_add_u32 s21, s6, 1835008
    v_mul_f32_e32 v96, v96, v104
    v_mul_f32_e64 v97, v97, v105
    v_mfma_f32_16x16x32_bf16 v[72:75], a[8:11], v[48:51], 0
    v_mul_f32_e64 v98, v98, v106
    v_mul_f32_e64 v99, v99, v107
    v_mfma_f32_16x16x32_bf16 v[92:95], a[12:15], v[52:55], 0
    v_mul_f32_e64 v100, v100, v108
    v_mul_f32_e64 v101, v101, v109
    v_mfma_f32_16x16x32_bf16 v[76:79], a[12:15], v[48:51], 0
    buffer_load_dwordx4 v22, s[36:39], s20 offen offset:2048 lds
    s_waitcnt lgkmcnt(2)
    v_mfma_f32_16x16x32_bf16 v[80:83], a[16:19], v[60:63], v[80:83]
    ds_read_b128 v[48:51], v17 offset:4096
    v_mul_f32_e32 v102, v102, v110
    v_mfma_f32_16x16x32_bf16 v[64:67], a[16:19], v[56:59], v[64:67]
    v_mul_f32_e64 v103, v103, v111
    v_cvt_pk_bf16_f32 v32, v96, v97
    v_mfma_f32_16x16x32_bf16 v[84:87], a[20:23], v[60:63], v[84:87]
    ds_read_b128 v[52:55], v17 offset:6144
    v_cvt_pk_bf16_f32 v33, v98, v99
    v_mfma_f32_16x16x32_bf16 v[68:71], a[20:23], v[56:59], v[68:71]
    buffer_load_dwordx4 v23, s[36:39], s20 offen offset:3072 lds
    v_mfma_f32_16x16x32_bf16 v[88:91], a[24:27], v[60:63], v[88:91]
    v_cvt_pk_bf16_f32 v34, v100, v101
    v_cvt_pk_bf16_f32 v35, v102, v103
    v_mfma_f32_16x16x32_bf16 v[72:75], a[24:27], v[56:59], v[72:75]
    v_mul_f32_e64 v112, v112, v120
    v_mul_f32_e64 v113, v113, v121
    v_mfma_f32_16x16x32_bf16 v[92:95], a[28:31], v[60:63], v[92:95]
    v_mul_f32_e64 v114, v114, v122
    v_mul_f32_e64 v115, v115, v123
    v_mfma_f32_16x16x32_bf16 v[76:79], a[28:31], v[56:59], v[76:79]
    v_mul_f32_e64 v116, v116, v124
    v_mul_f32_e64 v117, v117, v125
    s_waitcnt lgkmcnt(2)
    v_mfma_f32_16x16x32_bf16 v[80:83], a[32:35], v[44:47], v[80:83]
    ds_read_b128 v[56:59], v16 offset:8192
    v_mul_f32_e32 v118, v118, v126
    v_mfma_f32_16x16x32_bf16 v[64:67], a[32:35], v[40:43], v[64:67]
    s_add_u32 s18, s16, 0
    s_mov_b32 s49, 0
    s_atomic_add s49, s[24:25], s18 glc
    v_mfma_f32_16x16x32_bf16 v[84:87], a[36:39], v[44:47], v[84:87]
    ds_read_b128 v[60:63], v16 offset:10240
    v_mul_f32_e64 v119, v119, v127
    v_mfma_f32_16x16x32_bf16 v[68:71], a[36:39], v[40:43], v[68:71]
    v_cvt_pk_bf16_f32 v36, v112, v113
    v_cvt_pk_bf16_f32 v37, v114, v115
    v_mfma_f32_16x16x32_bf16 v[88:91], a[40:43], v[44:47], v[88:91]
    v_cvt_pk_bf16_f32 v38, v116, v117
    v_cvt_pk_bf16_f32 v39, v118, v119
    v_mfma_f32_16x16x32_bf16 v[72:75], a[40:43], v[40:43], v[72:75]
    buffer_store_dwordx4 v[32:35], v12, s[24:27], s21 offen sc0 sc1
    v_mfma_f32_16x16x32_bf16 v[92:95], a[44:47], v[44:47], v[92:95]
    v_mfma_f32_16x16x32_bf16 v[76:79], a[44:47], v[40:43], v[76:79]
    s_waitcnt lgkmcnt(2)
    v_mfma_f32_16x16x32_bf16 v[80:83], a[48:51], v[52:55], v[80:83]
    ds_read_b128 v[40:43], v17 offset:8192
    v_mfma_f32_16x16x32_bf16 v[64:67], a[48:51], v[48:51], v[64:67]
    buffer_store_dwordx4 v[36:39], v18, s[24:27], s21 offen sc0 sc1
    v_mfma_f32_16x16x32_bf16 v[84:87], a[52:55], v[52:55], v[84:87]
    ds_read_b128 v[44:47], v17 offset:10240
    v_mfma_f32_16x16x32_bf16 v[68:71], a[52:55], v[48:51], v[68:71]
    v_mfma_f32_16x16x32_bf16 v[88:91], a[56:59], v[52:55], v[88:91]
    v_mfma_f32_16x16x32_bf16 v[72:75], a[56:59], v[48:51], v[72:75]
    v_mfma_f32_16x16x32_bf16 v[92:95], a[60:63], v[52:55], v[92:95]
    s_waitcnt vmcnt(14)
    s_barrier
    v_mfma_f32_16x16x32_bf16 v[76:79], a[60:63], v[48:51], v[76:79]
    s_waitcnt lgkmcnt(2)
    v_mfma_f32_16x16x32_bf16 v[80:83], a[64:67], v[60:63], v[80:83]
    ds_read_b128 v[48:51], v16 offset:12288
    v_mfma_f32_16x16x32_bf16 v[64:67], a[64:67], v[56:59], v[64:67]
    v_mfma_f32_16x16x32_bf16 v[84:87], a[68:71], v[60:63], v[84:87]
    ds_read_b128 v[52:55], v16 offset:14336
    v_mfma_f32_16x16x32_bf16 v[68:71], a[68:71], v[56:59], v[68:71]
    v_mfma_f32_16x16x32_bf16 v[88:91], a[72:75], v[60:63], v[88:91]
    v_mfma_f32_16x16x32_bf16 v[72:75], a[72:75], v[56:59], v[72:75]
    v_mfma_f32_16x16x32_bf16 v[92:95], a[76:79], v[60:63], v[92:95]
    v_mfma_f32_16x16x32_bf16 v[76:79], a[76:79], v[56:59], v[76:79]
    s_waitcnt lgkmcnt(2)
    v_mfma_f32_16x16x32_bf16 v[80:83], a[80:83], v[44:47], v[80:83]
    ds_read_b128 v[56:59], v17 offset:12288
    v_mfma_f32_16x16x32_bf16 v[64:67], a[80:83], v[40:43], v[64:67]
    v_mfma_f32_16x16x32_bf16 v[84:87], a[84:87], v[44:47], v[84:87]
    ds_read_b128 v[60:63], v17 offset:14336
    v_mfma_f32_16x16x32_bf16 v[68:71], a[84:87], v[40:43], v[68:71]
    v_mfma_f32_16x16x32_bf16 v[88:91], a[88:91], v[44:47], v[88:91]
    s_cmp_eq_u32 s78, s76
    s_cbranch_scc0 L_retry_17
L_ok_16:
    v_mfma_f32_16x16x32_bf16 v[72:75], a[88:91], v[40:43], v[72:75]
    s_add_u32 m0, s13, 36864
    s_add_u32 s14, s5, 1376256
    v_mfma_f32_16x16x32_bf16 v[92:95], a[92:95], v[44:47], v[92:95]
    buffer_load_dwordx4 v5, s[24:27], s14 offen offset:0 sc1 lds
    v_mfma_f32_16x16x32_bf16 v[76:79], a[92:95], v[40:43], v[76:79]
    s_waitcnt lgkmcnt(2)
    v_mfma_f32_16x16x32_bf16 v[80:83], a[96:99], v[52:55], v[80:83]
    ds_read_b128 v[40:43], v16 offset:16384
    v_mfma_f32_16x16x32_bf16 v[64:67], a[96:99], v[48:51], v[64:67]
    s_add_u32 m0, s13, 40832
    s_add_u32 s14, s5, 1376256
    v_mfma_f32_16x16x32_bf16 v[84:87], a[100:103], v[52:55], v[84:87]
    ds_read_b128 v[44:47], v16 offset:18432
    v_mfma_f32_16x16x32_bf16 v[68:71], a[100:103], v[48:51], v[68:71]
    buffer_load_dwordx4 v5, s[24:27], s14 offen offset:128 sc1 lds
    v_mfma_f32_16x16x32_bf16 v[88:91], a[104:107], v[52:55], v[88:91]
    v_mfma_f32_16x16x32_bf16 v[72:75], a[104:107], v[48:51], v[72:75]
    v_mfma_f32_16x16x32_bf16 v[92:95], a[108:111], v[52:55], v[92:95]
    s_add_u32 m0, s13, 44800
    s_add_u32 s14, s5, 1376256
    v_mfma_f32_16x16x32_bf16 v[76:79], a[108:111], v[48:51], v[76:79]
    buffer_load_dwordx4 v5, s[24:27], s14 offen offset:256 sc1 lds
    s_waitcnt lgkmcnt(2)
    v_mfma_f32_16x16x32_bf16 v[80:83], a[112:115], v[60:63], v[80:83]
    ds_read_b128 v[48:51], v17 offset:16384
    v_mfma_f32_16x16x32_bf16 v[64:67], a[112:115], v[56:59], v[64:67]
    v_mfma_f32_16x16x32_bf16 v[84:87], a[116:119], v[60:63], v[84:87]
    ds_read_b128 v[52:55], v17 offset:18432
    v_mfma_f32_16x16x32_bf16 v[68:71], a[116:119], v[56:59], v[68:71]
    s_add_u32 m0, s13, 48768
    s_add_u32 s14, s5, 1376256
    v_mfma_f32_16x16x32_bf16 v[88:91], a[120:123], v[60:63], v[88:91]
    s_cmp_eq_u32 s49, s77
    s_cbranch_scc0 L_retry_20
L_ok_19:
    v_mfma_f32_16x16x32_bf16 v[72:75], a[120:123], v[56:59], v[72:75]
    buffer_load_dwordx4 v5, s[24:27], s14 offen offset:384 sc1 lds
    v_mfma_f32_16x16x32_bf16 v[92:95], a[124:127], v[60:63], v[92:95]
    v_mfma_f32_16x16x32_bf16 v[76:79], a[124:127], v[56:59], v[76:79]
    s_waitcnt lgkmcnt(2)
    v_mfma_f32_16x16x32_bf16 v[80:83], a[128:131], v[44:47], v[80:83]
    ds_read_b128 v[56:59], v16 offset:20480
    v_mfma_f32_16x16x32_bf16 v[64:67], a[128:131], v[40:43], v[64:67]
    s_add_u32 m0, s13, 52736
    s_add_u32 s14, s5, 1376256
    v_mfma_f32_16x16x32_bf16 v[84:87], a[132:135], v[44:47], v[84:87]
    ds_read_b128 v[60:63], v16 offset:22528
    v_mfma_f32_16x16x32_bf16 v[68:71], a[132:135], v[40:43], v[68:71]
    buffer_load_dwordx4 v5, s[24:27], s14 offen offset:512 sc1 lds
    v_mfma_f32_16x16x32_bf16 v[88:91], a[136:139], v[44:47], v[88:91]
    v_mfma_f32_16x16x32_bf16 v[72:75], a[136:139], v[40:43], v[72:75]
    v_mfma_f32_16x16x32_bf16 v[92:95], a[140:143], v[44:47], v[92:95]
    s_add_u32 m0, s13, 56704
    s_add_u32 s14, s5, 1376256
    v_mfma_f32_16x16x32_bf16 v[76:79], a[140:143], v[40:43], v[76:79]
    buffer_load_dwordx4 v5, s[24:27], s14 offen offset:640 sc1 lds
    s_waitcnt lgkmcnt(2)
    v_mfma_f32_16x16x32_bf16 v[80:83], a[144:147], v[52:55], v[80:83]
    ds_read_b128 v[40:43], v17 offset:20480
    v_mfma_f32_16x16x32_bf16 v[64:67], a[144:147], v[48:51], v[64:67]
    v_mfma_f32_16x16x32_bf16 v[84:87], a[148:151], v[52:55], v[84:87]
    ds_read_b128 v[44:47], v17 offset:22528
    v_mfma_f32_16x16x32_bf16 v[68:71], a[148:151], v[48:51], v[68:71]
    s_add_u32 s50, s7, 16384
    s_waitcnt vmcnt(6)
    s_atomic_add s3, s[24:25], s50
    v_mfma_f32_16x16x32_bf16 v[88:91], a[152:155], v[52:55], v[88:91]
    s_add_u32 m0, s13, 60672
    s_add_u32 s14, s5, 1376256
    v_mfma_f32_16x16x32_bf16 v[72:75], a[152:155], v[48:51], v[72:75]
    buffer_load_dwordx4 v5, s[24:27], s14 offen offset:768 sc1 lds
    v_mfma_f32_16x16x32_bf16 v[92:95], a[156:159], v[52:55], v[92:95]
    v_mfma_f32_16x16x32_bf16 v[76:79], a[156:159], v[48:51], v[76:79]
    s_waitcnt lgkmcnt(2)
    v_mfma_f32_16x16x32_bf16 v[80:83], a[160:163], v[60:63], v[80:83]
    ds_read_b128 v[48:51], v16 offset:24576
    v_mfma_f32_16x16x32_bf16 v[64:67], a[160:163], v[56:59], v[64:67]
    s_add_u32 m0, s9, 4096
    s_add_u32 s20, s8, 372736
    v_mfma_f32_16x16x32_bf16 v[84:87], a[164:167], v[60:63], v[84:87]
    ds_read_b128 v[52:55], v16 offset:26624
    v_mfma_f32_16x16x32_bf16 v[68:71], a[164:167], v[56:59], v[68:71]
    buffer_load_dwordx4 v20, s[36:39], s20 offen offset:0 lds
    v_mfma_f32_16x16x32_bf16 v[88:91], a[168:171], v[60:63], v[88:91]
    v_mfma_f32_16x16x32_bf16 v[72:75], a[168:171], v[56:59], v[72:75]
    v_mfma_f32_16x16x32_bf16 v[92:95], a[172:175], v[60:63], v[92:95]
    v_mfma_f32_16x16x32_bf16 v[76:79], a[172:175], v[56:59], v[76:79]
    buffer_load_dwordx4 v21, s[36:39], s20 offen offset:1024 lds
    s_waitcnt lgkmcnt(2)
    v_mfma_f32_16x16x32_bf16 v[80:83], a[176:179], v[44:47], v[80:83]
    ds_read_b128 v[56:59], v17 offset:24576
    v_mfma_f32_16x16x32_bf16 v[64:67], a[176:179], v[40:43], v[64:67]
    v_mfma_f32_16x16x32_bf16 v[84:87], a[180:183], v[44:47], v[84:87]
    ds_read_b128 v[60:63], v17 offset:26624
    v_mfma_f32_16x16x32_bf16 v[68:71], a[180:183], v[40:43], v[68:71]
    buffer_load_dwordx4 v22, s[36:39], s20 offen offset:2048 lds
    v_mfma_f32_16x16x32_bf16 v[88:91], a[184:187], v[44:47], v[88:91]
    v_mfma_f32_16x16x32_bf16 v[72:75], a[184:187], v[40:43], v[72:75]
    v_mfma_f32_16x16x32_bf16 v[92:95], a[188:191], v[44:47], v[92:95]
    v_mfma_f32_16x16x32_bf16 v[76:79], a[188:191], v[40:43], v[76:79]
    buffer_load_dwordx4 v23, s[36:39], s20 offen offset:3072 lds
    s_waitcnt lgkmcnt(2)
    v_mfma_f32_16x16x32_bf16 v[80:83], a[192:195], v[52:55], v[80:83]
    v_mfma_f32_16x16x32_bf16 v[64:67], a[192:195], v[48:51], v[64:67]
    v_mfma_f32_16x16x32_bf16 v[84:87], a[196:199], v[52:55], v[84:87]
    v_mfma_f32_16x16x32_bf16 v[68:71], a[196:199], v[48:51], v[68:71]
    v_mfma_f32_16x16x32_bf16 v[88:91], a[200:203], v[52:55], v[88:91]
    s_waitcnt vmcnt(8)
    ds_read_b32 v6, v14
    s_waitcnt lgkmcnt(1)
    s_barrier
    v_mfma_f32_16x16x32_bf16 v[72:75], a[200:203], v[48:51], v[72:75]
    ds_read_b128 v[40:43], v16 offset:36864
    v_mfma_f32_16x16x32_bf16 v[92:95], a[204:207], v[52:55], v[92:95]
    ds_read_b128 v[44:47], v16 offset:38912
    v_mfma_f32_16x16x32_bf16 v[76:79], a[204:207], v[48:51], v[76:79]
    buffer_load_dwordx4 a[224:227], v8, s[24:27], 0 offen offset:0 sc1
    v_mfma_f32_16x16x32_bf16 v[80:83], a[208:211], v[60:63], v[80:83]
    ds_read_b128 v[48:51], v17 offset:36864
    v_mfma_f32_16x16x32_bf16 v[64:67], a[208:211], v[56:59], v[64:67]
    v_mfma_f32_16x16x32_bf16 v[84:87], a[212:215], v[60:63], v[84:87]
    ds_read_b128 v[52:55], v17 offset:38912
    v_mfma_f32_16x16x32_bf16 v[68:71], a[212:215], v[56:59], v[68:71]
    v_mfma_f32_16x16x32_bf16 v[88:91], a[216:219], v[60:63], v[88:91]
    buffer_load_dwordx4 a[228:231], v8, s[24:27], 0 offen offset:1024 sc1
    v_mfma_f32_16x16x32_bf16 v[72:75], a[216:219], v[56:59], v[72:75]
    v_mfma_f32_16x16x32_bf16 v[92:95], a[220:223], v[60:63], v[92:95]
    v_mfma_f32_16x16x32_bf16 v[76:79], a[220:223], v[56:59], v[76:79]
    s_waitcnt lgkmcnt(2)
    v_mfma_f32_16x16x32_bf16 v[112:115], a[0:3], v[44:47], 0
    ds_read_b128 v[56:59], v16 offset:40960
    v_mfma_f32_16x16x32_bf16 v[96:99], a[0:3], v[40:43], 0
    buffer_load_dwordx4 a[232:235], v8, s[24:27], 0 offen offset:2048 sc1
    v_mfma_f32_16x16x32_bf16 v[116:119], a[4:7], v[44:47], 0
    ds_read_b128 v[60:63], v16 offset:43008
    v_mfma_f32_16x16x32_bf16 v[100:103], a[4:7], v[40:43], 0
    v_mfma_f32_16x16x32_bf16 v[120:123], a[8:11], v[44:47], 0
    s_add_u32 s18, s16, 16384
    s_mov_b32 s49, 0
    s_atomic_add s49, s[24:25], s18 glc
    v_mfma_f32_16x16x32_bf16 v[104:107], a[8:11], v[40:43], 0
    s_add_u32 s21, s6, 3670016
    v_mul_f32_e64 v64, v64, v72
    v_mul_f32_e64 v65, v65, v73
    v_mfma_f32_16x16x32_bf16 v[124:127], a[12:15], v[44:47], 0
    buffer_load_dwordx4 a[236:239], v8, s[24:27], 0 offen offset:3072 sc1
    v_mfma_f32_16x16x32_bf16 v[108:111], a[12:15], v[40:43], 0
    v_mul_f32_e64 v66, v66, v74
    v_mul_f32_e64 v67, v67, v75
    s_waitcnt lgkmcnt(2)
    v_mfma_f32_16x16x32_bf16 v[112:115], a[16:19], v[52:55], v[112:115]
    ds_read_b128 v[40:43], v17 offset:40960
    v_mul_f32_e32 v68, v68, v76
    v_mfma_f32_16x16x32_bf16 v[96:99], a[16:19], v[48:51], v[96:99]
    v_mul_f32_e64 v69, v69, v77
    v_mul_f32_e64 v70, v70, v78
    v_mfma_f32_16x16x32_bf16 v[116:119], a[20:23], v[52:55], v[116:119]
    ds_read_b128 v[44:47], v17 offset:43008
    v_mul_f32_e64 v71, v71, v79
    v_mfma_f32_16x16x32_bf16 v[100:103], a[20:23], v[48:51], v[100:103]
    buffer_load_dwordx4 a[240:243], v8, s[24:27], s72 offen offset:0 sc1
    v_mfma_f32_16x16x32_bf16 v[120:123], a[24:27], v[52:55], v[120:123]
    v_cvt_pk_bf16_f32 v32, v64, v65
    v_cvt_pk_bf16_f32 v33, v66, v67
    v_mfma_f32_16x16x32_bf16 v[104:107], a[24:27], v[48:51], v[104:107]
    v_cvt_pk_bf16_f32 v34, v68, v69
    v_cvt_pk_bf16_f32 v35, v70, v71
    v_mfma_f32_16x16x32_bf16 v[124:127], a[28:31], v[52:55], v[124:127]
    v_mul_f32_e64 v80, v80, v88
    v_mul_f32_e64 v81, v81, v89
    v_mfma_f32_16x16x32_bf16 v[108:111], a[28:31], v[48:51], v[108:111]
    v_mul_f32_e64 v82, v82, v90
    v_mul_f32_e64 v83, v83, v91
    s_waitcnt lgkmcnt(2)
    v_mfma_f32_16x16x32_bf16 v[112:115], a[32:35], v[60:63], v[112:115]
    ds_read_b128 v[48:51], v16 offset:45056
    v_mul_f32_e32 v84, v84, v92
    v_mfma_f32_16x16x32_bf16 v[96:99], a[32:35], v[56:59], v[96:99]
    buffer_load_dwordx4 a[244:247], v8, s[24:27], s72 offen offset:1024 sc1
    v_mfma_f32_16x16x32_bf16 v[116:119], a[36:39], v[60:63], v[116:119]
    ds_read_b128 v[52:55], v16 offset:47104
    v_mul_f32_e64 v85, v85, v93
    v_mfma_f32_16x16x32_bf16 v[100:103], a[36:39], v[56:59], v[100:103]
    v_mul_f32_e64 v86, v86, v94
    v_mul_f32_e64 v87, v87, v95
    v_mfma_f32_16x16x32_bf16 v[120:123], a[40:43], v[60:63], v[120:123]
    v_cvt_pk_bf16_f32 v36, v80, v81
    v_cvt_pk_bf16_f32 v37, v82, v83
    v_mfma_f32_16x16x32_bf16 v[104:107], a[40:43], v[56:59], v[104:107]
    v_cvt_pk_bf16_f32 v38, v84, v85
    v_cvt_pk_bf16_f32 v39, v86, v87
    v_mfma_f32_16x16x32_bf16 v[124:127], a[44:47], v[60:63], v[124:127]
    buffer_load_dwordx4 a[248:251], v8, s[24:27], s72 offen offset:2048 sc1
    v_mfma_f32_16x16x32_bf16 v[108:111], a[44:47], v[56:59], v[108:111]
    s_waitcnt lgkmcnt(2)
    v_mfma_f32_16x16x32_bf16 v[112:115], a[48:51], v[44:47], v[112:115]
    ds_read_b128 v[56:59], v17 offset:45056
    v_mfma_f32_16x16x32_bf16 v[96:99], a[48:51], v[40:43], v[96:99]
    v_mfma_f32_16x16x32_bf16 v[116:119], a[52:55], v[44:47], v[116:119]
    ds_read_b128 v[60:63], v17 offset:47104
    v_mfma_f32_16x16x32_bf16 v[100:103], a[52:55], v[40:43], v[100:103]
    buffer_load_dwordx4 a[252:255], v8, s[24:27], s72 offen offset:3072 sc1
    v_mfma_f32_16x16x32_bf16 v[120:123], a[56:59], v[44:47], v[120:123]
    v_mfma_f32_16x16x32_bf16 v[104:107], a[56:59], v[40:43], v[104:107]
    v_mfma_f32_16x16x32_bf16 v[124:127], a[60:63], v[44:47], v[124:127]
    s_waitcnt vmcnt(12)
    s_barrier
    v_mfma_f32_16x16x32_bf16 v[108:111], a[60:63], v[40:43], v[108:111]
    buffer_store_dwordx4 v[32:35], v12, s[24:27], s21 offen sc0 sc1
    s_waitcnt lgkmcnt(2)
    v_mfma_f32_16x16x32_bf16 v[112:115], a[64:67], v[52:55], v[112:115]
    ds_read_b128 v[40:43], v16 offset:49152
    v_mfma_f32_16x16x32_bf16 v[96:99], a[64:67], v[48:51], v[96:99]
    v_mfma_f32_16x16x32_bf16 v[116:119], a[68:71], v[52:55], v[116:119]
    ds_read_b128 v[44:47], v16 offset:51200
    v_mfma_f32_16x16x32_bf16 v[100:103], a[68:71], v[48:51], v[100:103]
    buffer_store_dwordx4 v[36:39], v18, s[24:27], s21 offen sc0 sc1
    v_mfma_f32_16x16x32_bf16 v[120:123], a[72:75], v[52:55], v[120:123]
    v_mfma_f32_16x16x32_bf16 v[104:107], a[72:75], v[48:51], v[104:107]
    v_mfma_f32_16x16x32_bf16 v[124:127], a[76:79], v[52:55], v[124:127]
    v_mfma_f32_16x16x32_bf16 v[108:111], a[76:79], v[48:51], v[108:111]
    s_waitcnt lgkmcnt(2)
    v_mfma_f32_16x16x32_bf16 v[112:115], a[80:83], v[60:63], v[112:115]
    ds_read_b128 v[48:51], v17 offset:49152
    v_mfma_f32_16x16x32_bf16 v[96:99], a[80:83], v[56:59], v[96:99]
    buffer_load_dwordx4 a[0:3], v8, s[24:27], s73 offen offset:0 sc1
    v_mfma_f32_16x16x32_bf16 v[116:119], a[84:87], v[60:63], v[116:119]
    ds_read_b128 v[52:55], v17 offset:51200
    v_mfma_f32_16x16x32_bf16 v[100:103], a[84:87], v[56:59], v[100:103]
    v_mfma_f32_16x16x32_bf16 v[120:123], a[88:91], v[60:63], v[120:123]
    v_mfma_f32_16x16x32_bf16 v[104:107], a[88:91], v[56:59], v[104:107]
    v_mfma_f32_16x16x32_bf16 v[124:127], a[92:95], v[60:63], v[124:127]
    buffer_load_dwordx4 a[4:7], v8, s[24:27], s73 offen offset:1024 sc1
    v_mfma_f32_16x16x32_bf16 v[108:111], a[92:95], v[56:59], v[108:111]
    s_waitcnt lgkmcnt(2)
    v_mfma_f32_16x16x32_bf16 v[112:115], a[96:99], v[44:47], v[112:115]
    ds_read_b128 v[56:59], v16 offset:53248
    v_mfma_f32_16x16x32_bf16 v[96:99], a[96:99], v[40:43], v[96:99]
    s_cmp_eq_u32 s49, s77
    s_cbranch_scc0 L_retry_23
L_ok_22:
    v_mfma_f32_16x16x32_bf16 v[116:119], a[100:103], v[44:47], v[116:119]
    ds_read_b128 v[60:63], v16 offset:55296
    v_mfma_f32_16x16x32_bf16 v[100:103], a[100:103], v[40:43], v[100:103]
    buffer_load_dwordx4 a[8:11], v8, s[24:27], s73 offen offset:2048 sc1
    v_mfma_f32_16x16x32_bf16 v[120:123], a[104:107], v[44:47], v[120:123]
    v_mfma_f32_16x16x32_bf16 v[104:107], a[104:107], v[40:43], v[104:107]
    v_mfma_f32_16x16x32_bf16 v[124:127], a[108:111], v[44:47], v[124:127]
    v_mfma_f32_16x16x32_bf16 v[108:111], a[108:111], v[40:43], v[108:111]
    s_waitcnt lgkmcnt(2)
    v_mfma_f32_16x16x32_bf16 v[112:115], a[112:115], v[52:55], v[112:115]
    ds_read_b128 v[40:43], v17 offset:53248
    v_mfma_f32_16x16x32_bf16 v[96:99], a[112:115], v[48:51], v[96:99]
    buffer_load_dwordx4 a[12:15], v8, s[24:27], s73 offen offset:3072 sc1
    v_mfma_f32_16x16x32_bf16 v[116:119], a[116:119], v[52:55], v[116:119]
    ds_read_b128 v[44:47], v17 offset:55296
    v_mfma_f32_16x16x32_bf16 v[100:103], a[116:119], v[48:51], v[100:103]
    v_mfma_f32_16x16x32_bf16 v[120:123], a[120:123], v[52:55], v[120:123]
    v_mfma_f32_16x16x32_bf16 v[104:107], a[120:123], v[48:51], v[104:107]
    v_mfma_f32_16x16x32_bf16 v[124:127], a[124:127], v[52:55], v[124:127]
    buffer_load_dwordx4 a[16:19], v8, s[24:27], s74 offen offset:0 sc1
    v_mfma_f32_16x16x32_bf16 v[108:111], a[124:127], v[48:51], v[108:111]
    s_waitcnt lgkmcnt(2)
    v_mfma_f32_16x16x32_bf16 v[112:115], a[128:131], v[60:63], v[112:115]
    ds_read_b128 v[48:51], v16 offset:57344
    v_mfma_f32_16x16x32_bf16 v[96:99], a[128:131], v[56:59], v[96:99]
    s_mov_b32 s78, 0
    s_atomic_add s78, s[24:25], s19 glc
    v_mfma_f32_16x16x32_bf16 v[116:119], a[132:135], v[60:63], v[116:119]
    ds_read_b128 v[52:55], v16 offset:59392
    v_mfma_f32_16x16x32_bf16 v[100:103], a[132:135], v[56:59], v[100:103]
    buffer_load_dwordx4 a[20:23], v8, s[24:27], s74 offen offset:1024 sc1
    v_mfma_f32_16x16x32_bf16 v[120:123], a[136:139], v[60:63], v[120:123]
    v_mfma_f32_16x16x32_bf16 v[104:107], a[136:139], v[56:59], v[104:107]
    v_mfma_f32_16x16x32_bf16 v[124:127], a[140:143], v[60:63], v[124:127]
    v_mfma_f32_16x16x32_bf16 v[108:111], a[140:143], v[56:59], v[108:111]
    s_waitcnt lgkmcnt(2)
    v_mfma_f32_16x16x32_bf16 v[112:115], a[144:147], v[44:47], v[112:115]
    ds_read_b128 v[56:59], v17 offset:57344
    v_mfma_f32_16x16x32_bf16 v[96:99], a[144:147], v[40:43], v[96:99]
    buffer_load_dwordx4 a[24:27], v9, s[24:27], 0 offen offset:0 sc1
    v_mfma_f32_16x16x32_bf16 v[116:119], a[148:151], v[44:47], v[116:119]
    ds_read_b128 v[60:63], v17 offset:59392
    v_mfma_f32_16x16x32_bf16 v[100:103], a[148:151], v[40:43], v[100:103]
    ds_read_b64_tr_b16 a[128:129], v24 offset:8192
    v_mfma_f32_16x16x32_bf16 v[120:123], a[152:155], v[44:47], v[120:123]
    ds_read_b64_tr_b16 a[130:131], v24 offset:8704
    v_mfma_f32_16x16x32_bf16 v[104:107], a[152:155], v[40:43], v[104:107]
    ds_read_b64_tr_b16 a[132:133], v25 offset:8192
    v_mfma_f32_16x16x32_bf16 v[124:127], a[156:159], v[44:47], v[124:127]
    buffer_load_dwordx4 a[28:31], v9, s[24:27], 0 offen offset:1024 sc1
    v_mfma_f32_16x16x32_bf16 v[108:111], a[156:159], v[40:43], v[108:111]
    ds_read_b64_tr_b16 a[134:135], v25 offset:8704
    s_waitcnt lgkmcnt(6)
    v_mfma_f32_16x16x32_bf16 v[112:115], a[160:163], v[52:55], v[112:115]
    ds_read_b128 v[40:43], v16 offset:61440
    v_mfma_f32_16x16x32_bf16 v[96:99], a[160:163], v[48:51], v[96:99]
    ds_read_b64_tr_b16 a[136:137], v26 offset:8192
    v_mfma_f32_16x16x32_bf16 v[116:119], a[164:167], v[52:55], v[116:119]
    ds_read_b128 v[44:47], v16 offset:63488
    v_mfma_f32_16x16x32_bf16 v[100:103], a[164:167], v[48:51], v[100:103]
    buffer_load_dwordx4 a[32:35], v9, s[24:27], 0 offen offset:2048 sc1
    v_mfma_f32_16x16x32_bf16 v[120:123], a[168:171], v[52:55], v[120:123]
    s_add_u32 s50, s7, 32768
    s_waitcnt vmcnt(9)
    s_atomic_add s3, s[24:25], s50
    v_mfma_f32_16x16x32_bf16 v[104:107], a[168:171], v[48:51], v[104:107]
    ds_read_b64_tr_b16 a[138:139], v26 offset:8704
    v_mfma_f32_16x16x32_bf16 v[124:127], a[172:175], v[52:55], v[124:127]
    ds_read_b64_tr_b16 a[140:141], v27 offset:8192
    v_mfma_f32_16x16x32_bf16 v[108:111], a[172:175], v[48:51], v[108:111]
    ds_read_b64_tr_b16 a[142:143], v27 offset:8704
    s_waitcnt lgkmcnt(10)
    v_mfma_f32_16x16x32_bf16 v[112:115], a[176:179], v[60:63], v[112:115]
    ds_read_b128 v[48:51], v17 offset:61440
    v_mfma_f32_16x16x32_bf16 v[96:99], a[176:179], v[56:59], v[96:99]
    buffer_load_dwordx4 a[36:39], v9, s[24:27], 0 offen offset:3072 sc1
    v_mfma_f32_16x16x32_bf16 v[116:119], a[180:183], v[60:63], v[116:119]
    ds_read_b128 v[52:55], v17 offset:63488
    v_mfma_f32_16x16x32_bf16 v[100:103], a[180:183], v[56:59], v[100:103]
    ds_read_b64_tr_b16 a[144:145], v24 offset:12288
    v_mfma_f32_16x16x32_bf16 v[120:123], a[184:187], v[60:63], v[120:123]
    ds_read_b64_tr_b16 a[146:147], v24 offset:12800
    v_mfma_f32_16x16x32_bf16 v[104:107], a[184:187], v[56:59], v[104:107]
    ds_read_b64_tr_b16 a[148:149], v25 offset:12288
    v_mfma_f32_16x16x32_bf16 v[124:127], a[188:191], v[60:63], v[124:127]
    buffer_load_dwordx4 a[40:43], v9, s[24:27], s72 offen offset:0 sc1
    v_mfma_f32_16x16x32_bf16 v[108:111], a[188:191], v[56:59], v[108:111]
    ds_read_b64_tr_b16 a[150:151], v25 offset:12800
    s_waitcnt lgkmcnt(9)
    v_mfma_f32_16x16x32_bf16 v[112:115], a[192:195], v[44:47], v[112:115]
    ds_read_b64_tr_b16 a[152:153], v26 offset:12288
    v_mfma_f32_16x16x32_bf16 v[96:99], a[192:195], v[40:43], v[96:99]
    ds_read_b64_tr_b16 a[154:155], v26 offset:12800
    v_mfma_f32_16x16x32_bf16 v[116:119], a[196:199], v[44:47], v[116:119]
    ds_read_b64_tr_b16 a[156:157], v27 offset:12288
    v_mfma_f32_16x16x32_bf16 v[100:103], a[196:199], v[40:43], v[100:103]
    buffer_load_dwordx4 a[44:47], v9, s[24:27], s72 offen offset:1024 sc1
    v_mfma_f32_16x16x32_bf16 v[120:123], a[200:203], v[44:47], v[120:123]
    ds_read_b64_tr_b16 a[158:159], v27 offset:12800
    v_mfma_f32_16x16x32_bf16 v[104:107], a[200:203], v[40:43], v[104:107]
    ds_read_b64_tr_b16 a[160:161], v24 offset:16384
    v_mfma_f32_16x16x32_bf16 v[124:127], a[204:207], v[44:47], v[124:127]
    ds_read_b64_tr_b16 a[162:163], v24 offset:16896
    v_mfma_f32_16x16x32_bf16 v[108:111], a[204:207], v[40:43], v[108:111]
    ds_read_b64_tr_b16 a[164:165], v25 offset:16384
    s_waitcnt lgkmcnt(11)
    v_mfma_f32_16x16x32_bf16 v[112:115], a[208:211], v[52:55], v[112:115]
    buffer_load_dwordx4 a[48:51], v9, s[24:27], s72 offen offset:2048 sc1
    v_mfma_f32_16x16x32_bf16 v[96:99], a[208:211], v[48:51], v[96:99]
    ds_read_b64_tr_b16 a[166:167], v25 offset:16896
    v_mfma_f32_16x16x32_bf16 v[116:119], a[212:215], v[52:55], v[116:119]
    ds_read_b64_tr_b16 a[168:169], v26 offset:16384
    v_mfma_f32_16x16x32_bf16 v[100:103], a[212:215], v[48:51], v[100:103]
    ds_read_b64_tr_b16 a[170:171], v26 offset:16896
    v_mfma_f32_16x16x32_bf16 v[120:123], a[216:219], v[52:55], v[120:123]
    ds_read_b64_tr_b16 a[172:173], v27 offset:16384
    v_mfma_f32_16x16x32_bf16 v[104:107], a[216:219], v[48:51], v[104:107]
    buffer_load_dwordx4 a[52:55], v9, s[24:27], s72 offen offset:3072 sc1
    v_mfma_f32_16x16x32_bf16 v[124:127], a[220:223], v[52:55], v[124:127]
    ds_read_b64_tr_b16 a[174:175], v27 offset:16896
    v_mfma_f32_16x16x32_bf16 v[108:111], a[220:223], v[48:51], v[108:111]
    ds_read_b64_tr_b16 a[176:177], v24 offset:20480
    buffer_load_dwordx4 a[56:59], v9, s[24:27], s73 offen offset:0 sc1
    buffer_load_dwordx4 a[60:63], v9, s[24:27], s73 offen offset:1024 sc1
    ds_read_b64_tr_b16 a[178:179], v24 offset:20992
    ds_read_b64_tr_b16 a[180:181], v25 offset:20480
    ds_read_b64_tr_b16 a[182:183], v25 offset:20992
    ds_read_b64_tr_b16 a[184:185], v26 offset:20480
    ds_read_b64_tr_b16 a[186:187], v26 offset:20992
    ds_read_b64_tr_b16 a[188:189], v27 offset:20480
    ds_read_b64_tr_b16 a[190:191], v27 offset:20992
    ds_read_b64_tr_b16 a[192:193], v24 offset:0
    ds_read_b64_tr_b16 a[194:195], v24 offset:512
    ds_read_b64_tr_b16 a[196:197], v25 offset:0
    ds_read_b64_tr_b16 a[198:199], v25 offset:512
    ds_read_b64_tr_b16 a[200:201], v26 offset:0
    ds_read_b64_tr_b16 a[202:203], v26 offset:512
    ds_read_b64_tr_b16 a[204:205], v27 offset:0
    ds_read_b64_tr_b16 a[206:207], v27 offset:512
    v_mfma_f32_16x16x32_bf16 v[64:67], v[128:131], a[224:227], 0
    s_add_u32 s18, s16, 32768
    s_mov_b32 s49, 0
    s_atomic_add s49, s[24:25], s18 glc
    v_mfma_f32_16x16x32_bf16 v[68:71], v[132:135], a[224:227], 0
    buffer_load_dwordx4 a[64:67], v9, s[24:27], s73 offen offset:2048 sc1
    v_mfma_f32_16x16x32_bf16 v[72:75], v[136:139], a[224:227], 0
    ds_read_b64_tr_b16 a[208:209], v24 offset:4096
    v_mfma_f32_16x16x32_bf16 v[76:79], v[140:143], a[224:227], 0
    ds_read_b64_tr_b16 a[210:211], v24 offset:4608
    v_mfma_f32_16x16x32_bf16 v[64:67], v[144:147], a[228:231], v[64:67]
    s_add_u32 s21, s6, 5505024
    v_mul_f32_e64 v96, v96, v104
    v_mul_f32_e64 v97, v97, v105
    v_mfma_f32_16x16x32_bf16 v[68:71], v[148:151], a[228:231], v[68:71]
    buffer_load_dwordx4 a[68:71], v9, s[24:27], s73 offen offset:3072 sc1
    v_mfma_f32_16x16x32_bf16 v[72:75], v[152:155], a[228:231], v[72:75]
    v_mul_f32_e64 v98, v98, v106
    v_mul_f32_e64 v99, v99, v107
    v_mfma_f32_16x16x32_bf16 v[76:79], v[156:159], a[228:231], v[76:79]
    v_mul_f32_e64 v100, v100, v108
    v_mul_f32_e64 v101, v101, v109
    v_mfma_f32_16x16x32_bf16 v[64:67], v[160:163], a[232:235], v[64:67]
    v_mul_f32_e64 v102, v102, v110
    v_mul_f32_e64 v103, v103, v111
    v_mfma_f32_16x16x32_bf16 v[68:71], v[164:167], a[232:235], v[68:71]
    buffer_load_dwordx4 a[72:75], v9, s[24:27], s74 offen offset:0 sc1
    v_mfma_f32_16x16x32_bf16 v[72:75], v[168:171], a[232:235], v[72:75]
    v_cvt_pk_bf16_f32 v32, v96, v97
    v_cvt_pk_bf16_f32 v33, v98, v99
    v_mfma_f32_16x16x32_bf16 v[76:79], v[172:175], a[232:235], v[76:79]
    v_cvt_pk_bf16_f32 v34, v100, v101
    v_cvt_pk_bf16_f32 v35, v102, v103
    v_mfma_f32_16x16x32_bf16 v[64:67], v[176:179], a[236:239], v[64:67]
    buffer_store_dwordx4 v[32:35], v12, s[24:27], s21 offen sc0 sc1
    v_mfma_f32_16x16x32_bf16 v[68:71], v[180:183], a[236:239], v[68:71]
    buffer_load_dwordx4 a[76:79], v9, s[24:27], s74 offen offset:1024 sc1
    v_mfma_f32_16x16x32_bf16 v[72:75], v[184:187], a[236:239], v[72:75]
    v_mul_f32_e64 v112, v112, v120
    v_mul_f32_e64 v113, v113, v121
    v_mfma_f32_16x16x32_bf16 v[76:79], v[188:191], a[236:239], v[76:79]
    v_mul_f32_e64 v114, v114, v122
    v_mul_f32_e64 v115, v115, v123
    v_mfma_f32_16x16x32_bf16 v[64:67], v[192:195], a[240:243], v[64:67]
    v_mul_f32_e64 v116, v116, v124
    v_mul_f32_e64 v117, v117, v125
    v_mfma_f32_16x16x32_bf16 v[68:71], v[196:199], a[240:243], v[68:71]
    v_mul_f32_e64 v118, v118, v126
    v_mul_f32_e64 v119, v119, v127
    v_mfma_f32_16x16x32_bf16 v[72:75], v[200:203], a[240:243], v[72:75]
    v_cvt_pk_bf16_f32 v36, v112, v113
    v_cvt_pk_bf16_f32 v37, v114, v115
    v_mfma_f32_16x16x32_bf16 v[76:79], v[204:207], a[240:243], v[76:79]
    v_cvt_pk_bf16_f32 v38, v116, v117
    v_cvt_pk_bf16_f32 v39, v118, v119
    v_mfma_f32_16x16x32_bf16 v[64:67], v[208:211], a[244:247], v[64:67]
    buffer_store_dwordx4 v[36:39], v18, s[24:27], s21 offen sc0 sc1
    v_mfma_f32_16x16x32_bf16 v[68:71], v[212:215], a[244:247], v[68:71]
    s_cmp_eq_u32 s78, s76
    s_cbranch_scc0 L_retry_26
L_ok_25:
    v_mfma_f32_16x16x32_bf16 v[72:75], v[216:219], a[244:247], v[72:75]
    ds_read_b64_tr_b16 a[212:213], v25 offset:4096
    v_mfma_f32_16x16x32_bf16 v[76:79], v[220:223], a[244:247], v[76:79]
    ds_read_b64_tr_b16 a[214:215], v25 offset:4608
    v_mfma_f32_16x16x32_bf16 v[64:67], v[224:227], a[248:251], v[64:67]
    s_add_u32 s22, s17, 1048576
    ds_read_b64_tr_b16 a[216:217], v26 offset:4096
    v_mfma_f32_16x16x32_bf16 v[68:71], v[228:231], a[248:251], v[68:71]
    buffer_load_dwordx2 v[104:105], v15, s[24:27], s22 offen sc1
    v_mfma_f32_16x16x32_bf16 v[72:75], v[232:235], a[248:251], v[72:75]
    ds_read_b64_tr_b16 a[218:219], v26 offset:4608
    v_mfma_f32_16x16x32_bf16 v[76:79], v[236:239], a[248:251], v[76:79]
    ds_read_b64_tr_b16 a[220:221], v27 offset:4096
    v_mfma_f32_16x16x32_bf16 v[64:67], v[240:243], a[252:255], v[64:67]
    s_mov_b32 s33, 0
    s_atomic_add s33, s[24:25], s18 glc
    v_mfma_f32_16x16x32_bf16 v[68:71], v[244:247], a[252:255], v[68:71]
    ds_read_b64_tr_b16 a[222:223], v27 offset:4608
    v_mfma_f32_16x16x32_bf16 v[72:75], v[248:251], a[252:255], v[72:75]
    v_mfma_f32_16x16x32_bf16 v[76:79], v[252:255], a[252:255], v[76:79]
    s_waitcnt vmcnt(22)
    v_mfma_f32_16x16x32_bf16 v[64:67], a[128:131], a[0:3], v[64:67]
    v_mfma_f32_16x16x32_bf16 v[68:71], a[132:135], a[0:3], v[68:71]
    v_mfma_f32_16x16x32_bf16 v[72:75], a[136:139], a[0:3], v[72:75]
    v_mfma_f32_16x16x32_bf16 v[76:79], a[140:143], a[0:3], v[76:79]
    s_waitcnt vmcnt(21) lgkmcnt(15)
    v_mfma_f32_16x16x32_bf16 v[64:67], a[144:147], a[4:7], v[64:67]
    v_mfma_f32_16x16x32_bf16 v[68:71], a[148:151], a[4:7], v[68:71]
    v_mfma_f32_16x16x32_bf16 v[72:75], a[152:155], a[4:7], v[72:75]
    v_mfma_f32_16x16x32_bf16 v[76:79], a[156:159], a[4:7], v[76:79]
    s_waitcnt vmcnt(20)
    v_mfma_f32_16x16x32_bf16 v[64:67], a[160:163], a[8:11], v[64:67]
    v_mfma_f32_16x16x32_bf16 v[68:71], a[164:167], a[8:11], v[68:71]
    v_mfma_f32_16x16x32_bf16 v[72:75], a[168:171], a[8:11], v[72:75]
    v_mfma_f32_16x16x32_bf16 v[76:79], a[172:175], a[8:11], v[76:79]
    s_waitcnt vmcnt(19)
    v_mfma_f32_16x16x32_bf16 v[64:67], a[176:179], a[12:15], v[64:67]
    s_cmp_eq_u32 s49, s77
    s_cbranch_scc0 L_retry_29
L_ok_28:
    v_mfma_f32_16x16x32_bf16 v[68:71], a[180:183], a[12:15], v[68:71]
    v_mfma_f32_16x16x32_bf16 v[72:75], a[184:187], a[12:15], v[72:75]
    v_mfma_f32_16x16x32_bf16 v[76:79], a[188:191], a[12:15], v[76:79]
    s_waitcnt vmcnt(18) lgkmcnt(14)
    v_mfma_f32_16x16x32_bf16 v[64:67], a[192:195], a[16:19], v[64:67]
    buffer_load_dwordx4 a[80:83], v10, s[24:27], 0 offen offset:0 sc1
    s_waitcnt lgkmcnt(12)
    v_mfma_f32_16x16x32_bf16 v[68:71], a[196:199], a[16:19], v[68:71]
    s_waitcnt lgkmcnt(10)
    v_mfma_f32_16x16x32_bf16 v[72:75], a[200:203], a[16:19], v[72:75]
    s_waitcnt lgkmcnt(8)
    v_mfma_f32_16x16x32_bf16 v[76:79], a[204:207], a[16:19], v[76:79]
    s_waitcnt vmcnt(18) lgkmcnt(6)
    v_mfma_f32_16x16x32_bf16 v[64:67], a[208:211], a[20:23], v[64:67]
    buffer_load_dwordx4 a[84:87], v10, s[24:27], 0 offen offset:1024 sc1
    s_waitcnt lgkmcnt(4)
    v_mfma_f32_16x16x32_bf16 v[68:71], a[212:215], a[20:23], v[68:71]
    s_waitcnt lgkmcnt(2)
    v_mfma_f32_16x16x32_bf16 v[72:75], a[216:219], a[20:23], v[72:75]
    ds_read_b32 v6, v14
    s_waitcnt lgkmcnt(1)
    v_mfma_f32_16x16x32_bf16 v[76:79], a[220:223], a[20:23], v[76:79]
    s_waitcnt vmcnt(18)
    v_mfma_f32_16x16x32_bf16 v[80:83], v[128:131], a[24:27], 0
    buffer_load_dwordx4 a[88:91], v10, s[24:27], 0 offen offset:2048 sc1
    v_mfma_f32_16x16x32_bf16 v[84:87], v[132:135], a[24:27], 0
    v_mfma_f32_16x16x32_bf16 v[88:91], v[136:139], a[24:27], 0
    v_mfma_f32_16x16x32_bf16 v[92:95], v[140:143], a[24:27], 0
    s_waitcnt vmcnt(18)
    v_mfma_f32_16x16x32_bf16 v[80:83], v[144:147], a[28:31], v[80:83]
    buffer_load_dwordx4 a[92:95], v10, s[24:27], 0 offen offset:3072 sc1
    v_mfma_f32_16x16x32_bf16 v[84:87], v[148:151], a[28:31], v[84:87]
    ds_write_b128 v13, v[64:67] offset:0
    v_mfma_f32_16x16x32_bf16 v[88:91], v[152:155], a[28:31], v[88:91]
    v_mfma_f32_16x16x32_bf16 v[92:95], v[156:159], a[28:31], v[92:95]
    ds_write_b128 v13, v[68:71] offset:64
    s_waitcnt vmcnt(18)
    v_mfma_f32_16x16x32_bf16 v[80:83], v[160:163], a[32:35], v[80:83]
    buffer_load_dwordx4 a[96:99], v10, s[24:27], s72 offen offset:0 sc1
    v_mfma_f32_16x16x32_bf16 v[84:87], v[164:167], a[32:35], v[84:87]
    s_add_u32 s50, s7, 49152
    s_waitcnt vmcnt(6)
    s_atomic_add s3, s[24:25], s50
    v_mfma_f32_16x16x32_bf16 v[88:91], v[168:171], a[32:35], v[88:91]
    ds_write_b128 v13, v[72:75] offset:128
    v_mfma_f32_16x16x32_bf16 v[92:95], v[172:175], a[32:35], v[92:95]
    v_mfma_f32_16x16x32_bf16 v[80:83], v[176:179], a[36:39], v[80:83]
    buffer_load_dwordx4 a[100:103], v10, s[24:27], s72 offen offset:1024 sc1
    v_mfma_f32_16x16x32_bf16 v[84:87], v[180:183], a[36:39], v[84:87]
    ds_write_b128 v13, v[76:79] offset:192
    v_mfma_f32_16x16x32_bf16 v[88:91], v[184:187], a[36:39], v[88:91]
    v_mfma_f32_16x16x32_bf16 v[92:95], v[188:191], a[36:39], v[92:95]
    v_mfma_f32_16x16x32_bf16 v[80:83], v[192:195], a[40:43], v[80:83]
    buffer_load_dwordx4 a[104:107], v10, s[24:27], s72 offen offset:2048 sc1
    v_mfma_f32_16x16x32_bf16 v[84:87], v[196:199], a[40:43], v[84:87]
    ds_read_b32 v6, v14
    s_waitcnt lgkmcnt(1)
    s_barrier
    v_mfma_f32_16x16x32_bf16 v[88:91], v[200:203], a[40:43], v[88:91]
    ds_read_b128 v[40:43], v14 offset:0
    v_mfma_f32_16x16x32_bf16 v[92:95], v[204:207], a[40:43], v[92:95]
    ds_read_b128 v[44:47], v14 offset:4352
    v_mfma_f32_16x16x32_bf16 v[80:83], v[208:211], a[44:47], v[80:83]
    buffer_load_dwordx4 a[108:111], v10, s[24:27], s72 offen offset:3072 sc1
    v_mfma_f32_16x16x32_bf16 v[84:87], v[212:215], a[44:47], v[84:87]
    ds_read_b128 v[48:51], v14 offset:8704
    v_mfma_f32_16x16x32_bf16 v[88:91], v[216:219], a[44:47], v[88:91]
    ds_read_b128 v[52:55], v14 offset:13056
    s_waitcnt vmcnt(8)
    v_lshlrev_b32_e64 v56, 16, v104
    v_mfma_f32_16x16x32_bf16 v[92:95], v[220:223], a[44:47], v[92:95]
    v_and_b32_e64 v57, s71, v104
    v_lshlrev_b32_e64 v58, 16, v105
    v_mfma_f32_16x16x32_bf16 v[80:83], v[224:227], a[48:51], v[80:83]
    s_add_u32 s18, s16, 49152
    s_mov_b32 s49, 0
    s_atomic_add s49, s[24:25], s18 glc
    v_mfma_f32_16x16x32_bf16 v[84:87], v[228:231], a[48:51], v[84:87]
    buffer_load_dwordx4 a[112:115], v10, s[24:27], s73 offen offset:0 sc1
    v_mfma_f32_16x16x32_bf16 v[88:91], v[232:235], a[48:51], v[88:91]
    v_and_b32_e32 v59, s71, v105
    v_mfma_f32_16x16x32_bf16 v[92:95], v[236:239], a[48:51], v[92:95]
    v_mfma_f32_16x16x32_bf16 v[80:83], v[240:243], a[52:55], v[80:83]
    v_mfma_f32_16x16x32_bf16 v[84:87], v[244:247], a[52:55], v[84:87]
    buffer_load_dwordx4 a[116:119], v10, s[24:27], s73 offen offset:1024 sc1
    v_mfma_f32_16x16x32_bf16 v[88:91], v[248:251], a[52:55], v[88:91]
    ds_read_b32 v6, v14
    ds_read_b32 v6, v14
    s_waitcnt lgkmcnt(2)
    s_add_u32 s23, s17, 0
    v_add_f32_e64 v40, v40, v44
    v_mfma_f32_16x16x32_bf16 v[92:95], v[252:255], a[52:55], v[92:95]
    v_add_f32_e64 v41, v41, v45
    v_add_f32_e64 v42, v42, v46
    v_mfma_f32_16x16x32_bf16 v[80:83], a[128:131], a[56:59], v[80:83]
    v_add_f32_e64 v43, v43, v47
    v_add_f32_e64 v48, v48, v52
    v_mfma_f32_16x16x32_bf16 v[84:87], a[132:135], a[56:59], v[84:87]
    buffer_load_dwordx4 a[120:123], v10, s[24:27], s73 offen offset:2048 sc1
    v_mfma_f32_16x16x32_bf16 v[88:91], a[136:139], a[56:59], v[88:91]
    v_add_f32_e64 v49, v49, v53
    v_add_f32_e64 v50, v50, v54
    v_mfma_f32_16x16x32_bf16 v[92:95], a[140:143], a[56:59], v[92:95]
    v_add_f32_e64 v51, v51, v55
    v_add_f32_e64 v40, v40, v48
    v_mfma_f32_16x16x32_bf16 v[80:83], a[144:147], a[60:63], v[80:83]
    v_add_f32_e64 v41, v41, v49
    v_add_f32_e64 v42, v42, v50
    v_mfma_f32_16x16x32_bf16 v[84:87], a[148:151], a[60:63], v[84:87]
    buffer_load_dwordx4 a[124:127], v10, s[24:27], s73 offen offset:3072 sc1
    v_mfma_f32_16x16x32_bf16 v[88:91], a[152:155], a[60:63], v[88:91]
    v_add_f32_e64 v43, v43, v51
    v_fma_f32 v40, v40, v28, v56
    v_mfma_f32_16x16x32_bf16 v[92:95], a[156:159], a[60:63], v[92:95]
    v_fma_f32 v41, v41, v29, v57
    v_fma_f32 v42, v42, v30, v58
    v_mfma_f32_16x16x32_bf16 v[80:83], a[160:163], a[64:67], v[80:83]
    v_fma_f32 v43, v43, v31, v59
    v_cvt_pk_bf16_f32 v60, v40, v41
    v_mfma_f32_16x16x32_bf16 v[84:87], a[164:167], a[64:67], v[84:87]
    buffer_load_dwordx4 v[96:99], v10, s[24:27], s74 offen offset:0 sc1
    v_mfma_f32_16x16x32_bf16 v[88:91], a[168:171], a[64:67], v[88:91]
    v_cvt_pk_bf16_f32 v61, v42, v43
    v_mfma_f32_16x16x32_bf16 v[92:95], a[172:175], a[64:67], v[92:95]
    buffer_store_dwordx2 v[60:61], v15, s[40:43], s23 offen
    v_mfma_f32_16x16x32_bf16 v[80:83], a[176:179], a[68:71], v[80:83]
    v_mfma_f32_16x16x32_bf16 v[84:87], a[180:183], a[68:71], v[84:87]
    buffer_load_dwordx4 v[100:103], v10, s[24:27], s74 offen offset:1024 sc1
    v_mfma_f32_16x16x32_bf16 v[88:91], a[184:187], a[68:71], v[88:91]
    v_mfma_f32_16x16x32_bf16 v[92:95], a[188:191], a[68:71], v[92:95]
    v_mfma_f32_16x16x32_bf16 v[80:83], a[192:195], a[72:75], v[80:83]
    s_add_u32 s22, s17, 1507328
    v_mfma_f32_16x16x32_bf16 v[84:87], a[196:199], a[72:75], v[84:87]
    buffer_load_dwordx2 v[106:107], v15, s[24:27], s22 offen sc1
    v_mfma_f32_16x16x32_bf16 v[88:91], a[200:203], a[72:75], v[88:91]
    v_mfma_f32_16x16x32_bf16 v[92:95], a[204:207], a[72:75], v[92:95]
    v_mfma_f32_16x16x32_bf16 v[80:83], a[208:211], a[76:79], v[80:83]
    s_mov_b32 s34, 0
    s_atomic_add s34, s[24:25], s18 glc
    v_mfma_f32_16x16x32_bf16 v[84:87], a[212:215], a[76:79], v[84:87]
    v_mfma_f32_16x16x32_bf16 v[88:91], a[216:219], a[76:79], v[88:91]
    v_mfma_f32_16x16x32_bf16 v[92:95], a[220:223], a[76:79], v[92:95]
    s_waitcnt vmcnt(15)
    v_mfma_f32_16x16x32_bf16 v[64:67], v[128:131], a[80:83], 0
    v_mfma_f32_16x16x32_bf16 v[68:71], v[132:135], a[80:83], 0
    v_mfma_f32_16x16x32_bf16 v[72:75], v[136:139], a[80:83], 0
    v_mfma_f32_16x16x32_bf16 v[76:79], v[140:143], a[80:83], 0
    s_waitcnt vmcnt(14)
    v_mfma_f32_16x16x32_bf16 v[64:67], v[144:147], a[84:87], v[64:67]
    ds_write_b128 v13, v[80:83] offset:17408
    v_mfma_f32_16x16x32_bf16 v[68:71], v[148:151], a[84:87], v[68:71]
    v_mfma_f32_16x16x32_bf16 v[72:75], v[152:155], a[84:87], v[72:75]
    ds_write_b128 v13, v[84:87] offset:17472
    v_mfma_f32_16x16x32_bf16 v[76:79], v[156:159], a[84:87], v[76:79]
    s_waitcnt vmcnt(13)
    v_mfma_f32_16x16x32_bf16 v[64:67], v[160:163], a[88:91], v[64:67]
    ds_write_b128 v13, v[88:91] offset:17536
    v_mfma_f32_16x16x32_bf16 v[68:71], v[164:167], a[88:91], v[68:71]
    v_mfma_f32_16x16x32_bf16 v[72:75], v[168:171], a[88:91], v[72:75]
    ds_write_b128 v13, v[92:95] offset:17600
    v_mfma_f32_16x16x32_bf16 v[76:79], v[172:175], a[88:91], v[76:79]
    s_waitcnt vmcnt(12)
    v_mfma_f32_16x16x32_bf16 v[64:67], v[176:179], a[92:95], v[64:67]
    s_cmp_eq_u32 s49, s77
    s_cbranch_scc0 L_retry_32
L_ok_31:
    s_add_u32 s22, s17, 1966080
    v_mfma_f32_16x16x32_bf16 v[68:71], v[180:183], a[92:95], v[68:71]
    buffer_load_dwordx2 v[108:109], v15, s[24:27], s22 offen sc1
    v_mfma_f32_16x16x32_bf16 v[72:75], v[184:187], a[92:95], v[72:75]
    ds_read_b32 v6, v14
    s_waitcnt lgkmcnt(1)
    s_barrier
    v_mfma_f32_16x16x32_bf16 v[76:79], v[188:191], a[92:95], v[76:79]
    ds_read_b128 v[40:43], v14 offset:17408
    s_waitcnt vmcnt(12)
    v_mfma_f32_16x16x32_bf16 v[64:67], v[192:195], a[96:99], v[64:67]
    ds_read_b128 v[44:47], v14 offset:21760
    v_mfma_f32_16x16x32_bf16 v[68:71], v[196:199], a[96:99], v[68:71]
    buffer_load_dwordx4 a[224:227], v11, s[24:27], 0 offen offset:0 sc1
    v_mfma_f32_16x16x32_bf16 v[72:75], v[200:203], a[96:99], v[72:75]
    ds_read_b128 v[48:51], v14 offset:26112
    v_mfma_f32_16x16x32_bf16 v[76:79], v[204:207], a[96:99], v[76:79]
    ds_read_b128 v[52:55], v14 offset:30464
    s_waitcnt vmcnt(12)
    v_mfma_f32_16x16x32_bf16 v[64:67], v[208:211], a[100:103], v[64:67]
    s_waitcnt vmcnt(2)
    v_lshlrev_b32_e64 v56, 16, v106
    v_and_b32_e64 v57, s71, v106
    v_mfma_f32_16x16x32_bf16 v[68:71], v[212:215], a[100:103], v[68:71]
    buffer_load_dwordx4 a[228:231], v11, s[24:27], 0 offen offset:1024 sc1
    v_mfma_f32_16x16x32_bf16 v[72:75], v[216:219], a[100:103], v[72:75]
    v_lshlrev_b32_e64 v58, 16, v107
    v_and_b32_e64 v59, s71, v107
    v_mfma_f32_16x16x32_bf16 v[76:79], v[220:223], a[100:103], v[76:79]
    v_mfma_f32_16x16x32_bf16 v[64:67], v[224:227], a[104:107], v[64:67]
    v_mfma_f32_16x16x32_bf16 v[68:71], v[228:231], a[104:107], v[68:71]
    buffer_load_dwordx4 a[232:235], v11, s[24:27], 0 offen offset:2048 sc1
    v_mfma_f32_16x16x32_bf16 v[72:75], v[232:235], a[104:107], v[72:75]
    ds_read_b32 v6, v14
    s_waitcnt lgkmcnt(1)
    s_add_u32 s23, s17, 458752
    v_add_f32_e32 v40, v40, v44
    v_mfma_f32_16x16x32_bf16 v[76:79], v[236:239], a[104:107], v[76:79]
    v_add_f32_e64 v41, v41, v45
    v_add_f32_e64 v42, v42, v46
    v_mfma_f32_16x16x32_bf16 v[64:67], v[240:243], a[108:111], v[64:67]
    v_add_f32_e64 v43, v43, v47
    v_add_f32_e64 v48, v48, v52
    v_mfma_f32_16x16x32_bf16 v[68:71], v[244:247], a[108:111], v[68:71]
    buffer_load_dwordx4 a[236:239], v11, s[24:27], 0 offen offset:3072 sc1
    v_mfma_f32_16x16x32_bf16 v[72:75], v[248:251], a[108:111], v[72:75]
    v_add_f32_e64 v49, v49, v53
    v_add_f32_e64 v50, v50, v54
    v_mfma_f32_16x16x32_bf16 v[76:79], v[252:255], a[108:111], v[76:79]
    v_add_f32_e64 v51, v51, v55
    v_add_f32_e64 v40, v40, v48
    v_mfma_f32_16x16x32_bf16 v[64:67], a[128:131], a[112:115], v[64:67]
    v_add_f32_e64 v41, v41, v49
    v_add_f32_e64 v42, v42, v50
    v_mfma_f32_16x16x32_bf16 v[68:71], a[132:135], a[112:115], v[68:71]
    buffer_load_dwordx4 a[240:243], v11, s[24:27], s72 offen offset:0 sc1
    v_mfma_f32_16x16x32_bf16 v[72:75], a[136:139], a[112:115], v[72:75]
    v_add_f32_e64 v43, v43, v51
    v_fma_f32 v40, v40, v28, v56
    v_mfma_f32_16x16x32_bf16 v[76:79], a[140:143], a[112:115], v[76:79]
    v_fma_f32 v41, v41, v29, v57
    v_fma_f32 v42, v42, v30, v58
    v_mfma_f32_16x16x32_bf16 v[64:67], a[144:147], a[116:119], v[64:67]
    v_fma_f32 v43, v43, v31, v59
    v_cvt_pk_bf16_f32 v60, v40, v41
    v_mfma_f32_16x16x32_bf16 v[68:71], a[148:151], a[116:119], v[68:71]
    buffer_load_dwordx4 a[244:247], v11, s[24:27], s72 offen offset:1024 sc1
    v_mfma_f32_16x16x32_bf16 v[72:75], a[152:155], a[116:119], v[72:75]
    v_cvt_pk_bf16_f32 v61, v42, v43
    v_mfma_f32_16x16x32_bf16 v[76:79], a[156:159], a[116:119], v[76:79]
    buffer_store_dwordx2 v[60:61], v15, s[40:43], s23 offen
    v_mfma_f32_16x16x32_bf16 v[64:67], a[160:163], a[120:123], v[64:67]
    v_mfma_f32_16x16x32_bf16 v[68:71], a[164:167], a[120:123], v[68:71]
    buffer_load_dwordx4 a[248:251], v11, s[24:27], s72 offen offset:2048 sc1
    v_mfma_f32_16x16x32_bf16 v[72:75], a[168:171], a[120:123], v[72:75]
    v_mfma_f32_16x16x32_bf16 v[76:79], a[172:175], a[120:123], v[76:79]
    v_mfma_f32_16x16x32_bf16 v[64:67], a[176:179], a[124:127], v[64:67]
    v_mfma_f32_16x16x32_bf16 v[68:71], a[180:183], a[124:127], v[68:71]
    buffer_load_dwordx4 a[252:255], v11, s[24:27], s72 offen offset:3072 sc1
    v_mfma_f32_16x16x32_bf16 v[72:75], a[184:187], a[124:127], v[72:75]
    v_mfma_f32_16x16x32_bf16 v[76:79], a[188:191], a[124:127], v[76:79]
    v_mfma_f32_16x16x32_bf16 v[64:67], a[192:195], v[96:99], v[64:67]
    v_mfma_f32_16x16x32_bf16 v[68:71], a[196:199], v[96:99], v[68:71]
    buffer_load_dwordx4 a[0:3], v11, s[24:27], s73 offen offset:0 sc1
    v_mfma_f32_16x16x32_bf16 v[72:75], a[200:203], v[96:99], v[72:75]
    v_mfma_f32_16x16x32_bf16 v[76:79], a[204:207], v[96:99], v[76:79]
    v_mfma_f32_16x16x32_bf16 v[64:67], a[208:211], v[100:103], v[64:67]
    v_mfma_f32_16x16x32_bf16 v[68:71], a[212:215], v[100:103], v[68:71]
    buffer_load_dwordx4 a[4:7], v11, s[24:27], s73 offen offset:1024 sc1
    v_mfma_f32_16x16x32_bf16 v[72:75], a[216:219], v[100:103], v[72:75]
    v_mfma_f32_16x16x32_bf16 v[76:79], a[220:223], v[100:103], v[76:79]
    s_waitcnt vmcnt(10)
    v_mfma_f32_16x16x32_bf16 v[80:83], v[128:131], a[224:227], 0
    v_mfma_f32_16x16x32_bf16 v[84:87], v[132:135], a[224:227], 0
    buffer_load_dwordx4 a[8:11], v11, s[24:27], s73 offen offset:2048 sc1
    v_mfma_f32_16x16x32_bf16 v[88:91], v[136:139], a[224:227], 0
    v_mfma_f32_16x16x32_bf16 v[92:95], v[140:143], a[224:227], 0
    s_waitcnt vmcnt(10)
    v_mfma_f32_16x16x32_bf16 v[80:83], v[144:147], a[228:231], v[80:83]
    ds_write_b128 v13, v[64:67] offset:0
    v_mfma_f32_16x16x32_bf16 v[84:87], v[148:151], a[228:231], v[84:87]
    buffer_load_dwordx4 a[12:15], v11, s[24:27], s73 offen offset:3072 sc1
    v_mfma_f32_16x16x32_bf16 v[88:91], v[152:155], a[228:231], v[88:91]
    ds_write_b128 v13, v[68:71] offset:64
    v_mfma_f32_16x16x32_bf16 v[92:95], v[156:159], a[228:231], v[92:95]
    s_waitcnt vmcnt(10)
    v_mfma_f32_16x16x32_bf16 v[80:83], v[160:163], a[232:235], v[80:83]
    ds_write_b128 v13, v[72:75] offset:128
    v_mfma_f32_16x16x32_bf16 v[84:87], v[164:167], a[232:235], v[84:87]
    buffer_load_dwordx4 a[16:19], v11, s[24:27], s74 offen offset:0 sc1
    v_mfma_f32_16x16x32_bf16 v[88:91], v[168:171], a[232:235], v[88:91]
    ds_write_b128 v13, v[76:79] offset:192
    v_mfma_f32_16x16x32_bf16 v[92:95], v[172:175], a[232:235], v[92:95]
    s_waitcnt vmcnt(10)
    v_mfma_f32_16x16x32_bf16 v[80:83], v[176:179], a[236:239], v[80:83]
    v_mfma_f32_16x16x32_bf16 v[84:87], v[180:183], a[236:239], v[84:87]
    buffer_load_dwordx4 a[20:23], v11, s[24:27], s74 offen offset:1024 sc1
    v_mfma_f32_16x16x32_bf16 v[88:91], v[184:187], a[236:239], v[88:91]
    s_add_u32 s22, s17, 2424832
    s_waitcnt lgkmcnt(0)
    s_barrier
    v_mfma_f32_16x16x32_bf16 v[92:95], v[188:191], a[236:239], v[92:95]
    buffer_load_dwordx2 v[110:111], v15, s[24:27], s22 offen sc1
    s_waitcnt vmcnt(11)
    v_mfma_f32_16x16x32_bf16 v[80:83], v[192:195], a[240:243], v[80:83]
    ds_read_b128 v[40:43], v14 offset:0
    v_mfma_f32_16x16x32_bf16 v[84:87], v[196:199], a[240:243], v[84:87]
    ds_read_b128 v[44:47], v14 offset:4352
    v_mfma_f32_16x16x32_bf16 v[88:91], v[200:203], a[240:243], v[88:91]
    ds_read_b128 v[48:51], v14 offset:8704
    v_mfma_f32_16x16x32_bf16 v[92:95], v[204:207], a[240:243], v[92:95]
    ds_read_b128 v[52:55], v14 offset:13056
    s_waitcnt vmcnt(10)
    v_mfma_f32_16x16x32_bf16 v[80:83], v[208:211], a[244:247], v[80:83]
    v_lshlrev_b32_e64 v56, 16, v108
    v_and_b32_e64 v57, s71, v108
    v_mfma_f32_16x16x32_bf16 v[84:87], v[212:215], a[244:247], v[84:87]
    v_lshlrev_b32_e64 v58, 16, v109
    v_and_b32_e64 v59, s71, v109
    v_mfma_f32_16x16x32_bf16 v[88:91], v[216:219], a[244:247], v[88:91]
    v_mfma_f32_16x16x32_bf16 v[92:95], v[220:223], a[244:247], v[92:95]
    s_waitcnt vmcnt(8)
    v_mfma_f32_16x16x32_bf16 v[80:83], v[224:227], a[248:251], v[80:83]
    s_waitcnt lgkmcnt(0)
    s_add_u32 s23, s17, 917504
    v_add_f32_e64 v40, v40, v44
    v_mfma_f32_16x16x32_bf16 v[84:87], v[228:231], a[248:251], v[84:87]
    v_add_f32_e64 v41, v41, v45
    v_add_f32_e64 v42, v42, v46
    v_mfma_f32_16x16x32_bf16 v[88:91], v[232:235], a[248:251], v[88:91]
    v_add_f32_e64 v43, v43, v47
    v_add_f32_e64 v48, v48, v52
    v_mfma_f32_16x16x32_bf16 v[92:95], v[236:239], a[248:251], v[92:95]
    v_add_f32_e64 v49, v49, v53
    v_add_f32_e64 v50, v50, v54
    s_waitcnt vmcnt(7)
    v_mfma_f32_16x16x32_bf16 v[80:83], v[240:243], a[252:255], v[80:83]
    v_add_f32_e32 v51, v51, v55
    v_add_f32_e64 v40, v40, v48
    v_mfma_f32_16x16x32_bf16 v[84:87], v[244:247], a[252:255], v[84:87]
    v_add_f32_e64 v41, v41, v49
    v_add_f32_e64 v42, v42, v50
    v_mfma_f32_16x16x32_bf16 v[88:91], v[248:251], a[252:255], v[88:91]
    v_add_f32_e64 v43, v43, v51
    v_fma_f32 v40, v40, v28, v56
    v_mfma_f32_16x16x32_bf16 v[92:95], v[252:255], a[252:255], v[92:95]
    v_fma_f32 v41, v41, v29, v57
    v_fma_f32 v42, v42, v30, v58
    s_waitcnt vmcnt(6)
    v_mfma_f32_16x16x32_bf16 v[80:83], a[128:131], a[0:3], v[80:83]
    v_fma_f32 v43, v43, v31, v59
    v_cvt_pk_bf16_f32 v60, v40, v41
    v_mfma_f32_16x16x32_bf16 v[84:87], a[132:135], a[0:3], v[84:87]
    v_cvt_pk_bf16_f32 v61, v42, v43
    v_mfma_f32_16x16x32_bf16 v[88:91], a[136:139], a[0:3], v[88:91]
    buffer_store_dwordx2 v[60:61], v15, s[40:43], s23 offen
    v_mfma_f32_16x16x32_bf16 v[92:95], a[140:143], a[0:3], v[92:95]
    s_waitcnt vmcnt(6)
    v_mfma_f32_16x16x32_bf16 v[80:83], a[144:147], a[4:7], v[80:83]
    v_mfma_f32_16x16x32_bf16 v[84:87], a[148:151], a[4:7], v[84:87]
    v_mfma_f32_16x16x32_bf16 v[88:91], a[152:155], a[4:7], v[88:91]
    v_mfma_f32_16x16x32_bf16 v[92:95], a[156:159], a[4:7], v[92:95]
    s_waitcnt vmcnt(5)
    v_mfma_f32_16x16x32_bf16 v[80:83], a[160:163], a[8:11], v[80:83]
    v_mfma_f32_16x16x32_bf16 v[84:87], a[164:167], a[8:11], v[84:87]
    v_mfma_f32_16x16x32_bf16 v[88:91], a[168:171], a[8:11], v[88:91]
    v_mfma_f32_16x16x32_bf16 v[92:95], a[172:175], a[8:11], v[92:95]
    s_waitcnt vmcnt(4)
    v_mfma_f32_16x16x32_bf16 v[80:83], a[176:179], a[12:15], v[80:83]
    v_mfma_f32_16x16x32_bf16 v[84:87], a[180:183], a[12:15], v[84:87]
    v_mfma_f32_16x16x32_bf16 v[88:91], a[184:187], a[12:15], v[88:91]
    v_mfma_f32_16x16x32_bf16 v[92:95], a[188:191], a[12:15], v[92:95]
    s_waitcnt vmcnt(3)
    v_mfma_f32_16x16x32_bf16 v[80:83], a[192:195], a[16:19], v[80:83]
    v_mfma_f32_16x16x32_bf16 v[84:87], a[196:199], a[16:19], v[84:87]
    v_mfma_f32_16x16x32_bf16 v[88:91], a[200:203], a[16:19], v[88:91]
    v_mfma_f32_16x16x32_bf16 v[92:95], a[204:207], a[16:19], v[92:95]
    s_waitcnt vmcnt(2)
    v_mfma_f32_16x16x32_bf16 v[80:83], a[208:211], a[20:23], v[80:83]
    v_mfma_f32_16x16x32_bf16 v[84:87], a[212:215], a[20:23], v[84:87]
    v_mfma_f32_16x16x32_bf16 v[88:91], a[216:219], a[20:23], v[88:91]
    v_mfma_f32_16x16x32_bf16 v[92:95], a[220:223], a[20:23], v[92:95]
    s_nop 0
    s_waitcnt vmcnt(1)
    v_lshlrev_b32_e64 v56, 16, v110
    v_and_b32_e64 v57, s71, v110
    v_lshlrev_b32_e64 v58, 16, v111
    v_and_b32_e64 v59, s71, v111
    ds_write_b128 v13, v[80:83] offset:17408
    ds_write_b128 v13, v[84:87] offset:17472
    ds_write_b128 v13, v[88:91] offset:17536
    ds_write_b128 v13, v[92:95] offset:17600
    s_waitcnt lgkmcnt(0)
    s_barrier
    ds_read_b128 v[40:43], v14 offset:17408
    ds_read_b128 v[44:47], v14 offset:21760
    ds_read_b128 v[48:51], v14 offset:26112
    ds_read_b128 v[52:55], v14 offset:30464
    s_nop 0
    s_waitcnt lgkmcnt(0)
    s_add_u32 s23, s17, 1376256
    v_add_f32_e64 v40, v40, v44
    v_add_f32_e64 v41, v41, v45
    v_add_f32_e64 v42, v42, v46
    v_add_f32_e64 v43, v43, v47
    v_add_f32_e64 v48, v48, v52
    v_add_f32_e64 v49, v49, v53
    v_add_f32_e64 v50, v50, v54
    v_add_f32_e64 v51, v51, v55
    v_add_f32_e64 v40, v40, v48
    v_add_f32_e64 v41, v41, v49
    v_add_f32_e64 v42, v42, v50
    v_add_f32_e64 v43, v43, v51
    v_fma_f32 v40, v40, v28, v56
    v_fma_f32 v41, v41, v29, v57
    v_fma_f32 v42, v42, v30, v58
    v_fma_f32 v43, v43, v31, v59
    v_cvt_pk_bf16_f32 v60, v40, v41
    v_cvt_pk_bf16_f32 v61, v42, v43
    buffer_store_dwordx2 v[60:61], v15, s[40:43], s23 offen
L_end:
L_exit:
    s_endpgm
L_mod:
    s_load_dwordx2 s[44:45], s[0:1], 80
    s_load_dwordx2 s[48:49], s[0:1], 88
    s_load_dwordx2 s[16:17], s[0:1], 0
    s_load_dwordx2 s[24:25], s[0:1], 112
    s_getpc_b64 s[52:53]
L_pc_34:
    s_sub_u32 s52, s52, L_pc_34-L_begin
    s_subb_u32 s53, s53, 0
    s_mov_b32 s54, L_code_end-L_begin
    s_mov_b32 s55, 0x20000
    s_and_b32 s58, s2, 7
    s_lshl_b32 s64, s59, 7
    v_lshlrev_b32 v5, 12, v0
    buffer_load_dword a248, v5, s[52:55], s64 offen
    v_lshrrev_b32 v2, 6, v0
    v_and_b32 v1, 63, v0
    s_mov_b32 s70, 0
    s_mov_b32 s3, 1
    s_nop 0
    v_readfirstlane_b32 s60, v2
    s_mov_b32 s71, 0xffff0000
    s_mov_b32 s46, 896
    s_mov_b32 s47, 0x20000
    s_mov_b32 s50, 2408448
    s_mov_b32 s51, 0x20000
    s_mov_b32 s18, 1835008
    s_mov_b32 s19, 0x20000
    s_mov_b32 s26, 20152320
    s_mov_b32 s27, 0x20000
    s_sub_u32 s64, s59, 28
    s_lshl_b32 s56, s64, 3
    s_add_u32 s56, s56, s58
    s_lshl_b32 s65, s58, 2
    s_add_u32 s64, s64, s65
    s_lshl_b32 s64, s64, 2
    s_add_u32 s57, s64, s60
    s_cmp_ge_u32 s56, 21
    s_cselect_b32 s50, 0, s50
    v_lshlrev_b32 v7, 2, v0
    v_lshrrev_b32_e64 v9, 4, v0
    v_mul_u32_u24 v10, 150528, v9
    v_and_b32_e64 v11, 15, v0
    v_lshl_add_u32 v10, v11, 4, v10
    s_lshl_b32 s66, s56, 8
    s_waitcnt lgkmcnt(0)
    buffer_load_dword v8, v7, s[44:47], 0 offen
    s_load_dword s63, s[24:25], 0
    buffer_load_dwordx4 v[128:131], v10, s[48:51], s66 offen
    s_add_u32 s66, s66, 5376
    buffer_load_dwordx4 v[132:135], v10, s[48:51], s66 offen
    s_add_u32 s66, s66, 5376
    buffer_load_dwordx4 v[136:139], v10, s[48:51], s66 offen
    s_add_u32 s66, s66, 5376
    buffer_load_dwordx4 v[140:143], v10, s[48:51], s66 offen
    s_add_u32 s66, s66, 5376
    buffer_load_dwordx4 v[144:147], v10, s[48:51], s66 offen
    s_add_u32 s66, s66, 5376
    buffer_load_dwordx4 v[148:151], v10, s[48:51], s66 offen
    s_add_u32 s66, s66, 5376
    buffer_load_dwordx4 v[152:155], v10, s[48:51], s66 offen
    s_add_u32 s66, s66, 5376
    buffer_load_dwordx4 v[156:159], v10, s[48:51], s66 offen
    s_add_u32 s66, s66, 5376
    v_lshlrev_b32 v14, 4, v1
    s_waitcnt vmcnt(8)
    v_lshlrev_b32 v112, 16, v8
    v_and_b32 v113, s71, v8
    v_mul_f32 v114, 0xbfb8aa3b, v112
    v_mul_f32 v115, 0xbfb8aa3b, v113
    v_exp_f32 v114, v114
    v_exp_f32 v115, v115
    v_add_f32 v114, 1.0, v114
    v_add_f32 v115, 1.0, v115
    v_rcp_f32 v114, v114
    v_rcp_f32 v115, v115
    v_mul_f32 v112, v112, v114
    v_mul_f32 v113, v113, v115
    v_cvt_pk_bf16_f32 v116, v112, v113
    v_and_b32 v112, 0xffff, v116
    v_lshlrev_b32 v113, 16, v116
    v_lshrrev_b32 v114, 16, v116
    v_and_b32 v115, s71, v116
    v_lshlrev_b32 v12, 4, v0
    v_mul_u32_u24 v13, 224, v9
    ds_write_b128 v12, v[112:115] offset:9472
    buffer_load_dwordx4 v[160:163], v10, s[48:51], s66 offen
    s_add_u32 s66, s66, 5376
    buffer_load_dwordx4 v[164:167], v10, s[48:51], s66 offen
    s_add_u32 s66, s66, 5376
    ds_read_b32 v15, v14
    s_waitcnt lgkmcnt(1)
    s_barrier
    ds_read_b128 v[64:67], v13 offset:9472
    ds_read_b128 v[68:71], v13 offset:9488
    ds_read_b128 v[72:75], v13 offset:9504
    ds_read_b128 v[76:79], v13 offset:9520
    ds_read_b128 v[80:83], v13 offset:9536
    ds_read_b128 v[84:87], v13 offset:9552
    ds_read_b128 v[88:91], v13 offset:9568
    ds_read_b128 v[92:95], v13 offset:9584
    ds_read_b128 v[96:99], v13 offset:9600
    ds_read_b128 v[100:103], v13 offset:9616
    ds_read_b128 v[104:107], v13 offset:9632
    ds_read_b128 v[108:111], v13 offset:9648
    ds_read_b128 v[112:115], v13 offset:9664
    ds_read_b128 v[116:119], v13 offset:9680
    buffer_load_dwordx4 v[168:171], v10, s[48:51], s66 offen
    s_add_u32 s66, s66, 5376
    s_nop 0
    s_waitcnt vmcnt(10) lgkmcnt(13)
    v_dot2_f32_bf16 v120, v128, v64, 0
    v_dot2_f32_bf16 v121, v128, v65, 0
    v_dot2_f32_bf16 v122, v129, v64, 0
    v_dot2_f32_bf16 v123, v129, v65, 0
    v_dot2_f32_bf16 v124, v130, v64, 0
    v_dot2_f32_bf16 v125, v130, v65, 0
    v_dot2_f32_bf16 v126, v131, v64, 0
    v_dot2_f32_bf16 v127, v131, v65, 0
    buffer_load_dwordx4 v[172:175], v10, s[48:51], s66 offen
    s_add_u32 s66, s66, 5376
    s_nop 0
    s_waitcnt vmcnt(10)
    v_dot2_f32_bf16 v120, v132, v66, v120
    v_dot2_f32_bf16 v121, v132, v67, v121
    v_dot2_f32_bf16 v122, v133, v66, v122
    v_dot2_f32_bf16 v123, v133, v67, v123
    v_dot2_f32_bf16 v124, v134, v66, v124
    v_dot2_f32_bf16 v125, v134, v67, v125
    v_dot2_f32_bf16 v126, v135, v66, v126
    v_dot2_f32_bf16 v127, v135, v67, v127
    buffer_load_dwordx4 v[176:179], v10, s[48:51], s66 offen
    s_add_u32 s66, s66, 5376
    s_nop 0
    s_waitcnt vmcnt(10) lgkmcnt(12)
    v_dot2_f32_bf16 v120, v136, v68, v120
    v_dot2_f32_bf16 v121, v136, v69, v121
    v_dot2_f32_bf16 v122, v137, v68, v122
    v_dot2_f32_bf16 v123, v137, v69, v123
    v_dot2_f32_bf16 v124, v138, v68, v124
    v_dot2_f32_bf16 v125, v138, v69, v125
    v_dot2_f32_bf16 v126, v139, v68, v126
    v_dot2_f32_bf16 v127, v139, v69, v127
    buffer_load_dwordx4 v[180:183], v10, s[48:51], s66 offen
    s_add_u32 s66, s66, 5376
    s_nop 0
    s_waitcnt vmcnt(10)
    v_dot2_f32_bf16 v120, v140, v70, v120
    v_dot2_f32_bf16 v121, v140, v71, v121
    v_dot2_f32_bf16 v122, v141, v70, v122
    v_dot2_f32_bf16 v123, v141, v71, v123
    v_dot2_f32_bf16 v124, v142, v70, v124
    v_dot2_f32_bf16 v125, v142, v71, v125
    v_dot2_f32_bf16 v126, v143, v70, v126
    v_dot2_f32_bf16 v127, v143, v71, v127
    buffer_load_dwordx4 v[184:187], v10, s[48:51], s66 offen
    s_add_u32 s66, s66, 5376
    v_mov_b32 v4, 1073741824
    v_cmp_ne_u32 vcc, 0, v1
    s_nop 1
    v_cndmask_b32 v4, 0, v4, vcc
    s_mul_i32 s64, s57, 3584
    v_lshlrev_b32 v14, 4, v1
    v_mov_b32 v16, 1073741824
    v_cmp_gt_u32 vcc, 56, v1
    s_lshr_b32 s65, s57, 2
    s_lshl_b32 s65, s65, 7
    s_add_u32 s4, s65, 8454144
    v_cndmask_b32 v5, v16, v14, vcc
    v_add_u32 v3, s64, v5
    s_lshl_b32 s5, s60, 13
    s_lshl_b32 s6, s60, 14
    s_add_u32 s6, s6, 65536
    s_lshr_b32 s8, s57, 1
    s_mul_i32 s8, s8, 256
    s_add_u32 s8, s8, 19922944
    s_mov_b32 s9, 0x3f803f80
    s_mov_b32 s10, 0x3b124925
    s_mov_b32 s11, 0x3727c5ac
    v_bfe_u32 v16, v1, 3, 1
    v_lshrrev_b32_e64 v17, 4, v1
    v_lshl_add_u32 v16, v16, 2, v17
    v_mul_u32_u24 v16, 8320, v16
    v_and_b32_e64 v17, 7, v1
    v_lshl_add_u32 v240, v17, 4, v16
    s_mul_i32 s64, s60, 532480
    s_add_u32 s4, s4, s64
    s_cmp_eq_u32 s60, 3
    s_cselect_b32 s78, 1073741824, s4
    s_lshl_b32 s64, s60, 1
    v_lshrrev_b32 v16, 1, v1
    v_xor_b32 v18, s64, v16
    v_and_b32 v18, 7, v18
    v_lshlrev_b32 v18, 4, v18
    v_and_b32_e64 v17, 1, v1
    v_lshl_add_u32 v18, v17, 7, v18
    v_lshl_add_u32 v242, v16, 10, v18
    v_xor_b32 v243, 16, v242
    v_add_u32 v252, s6, v14
    s_lshr_b32 s65, s57, 5
    s_mul_i32 s65, s65, 256
    s_add_u32 s65, s65, 20086784
    s_lshl_b32 s64, s60, 2
    s_add_u32 s64, s64, 0
    s_min_u32 s64, s64, 13
    s_mul_i32 s64, s64, 1024
    s_add_u32 s12, s64, s65
    s_lshl_b32 s64, s60, 2
    s_add_u32 s64, s64, 1
    s_min_u32 s64, s64, 13
    s_mul_i32 s64, s64, 1024
    s_add_u32 s13, s64, s65
    s_lshl_b32 s64, s60, 2
    s_add_u32 s64, s64, 2
    s_min_u32 s64, s64, 13
    s_mul_i32 s64, s64, 1024
    s_add_u32 s14, s64, s65
    s_lshl_b32 s64, s60, 2
    s_add_u32 s64, s64, 3
    s_min_u32 s64, s64, 13
    s_mul_i32 s64, s64, 1024
    s_add_u32 s15, s64, s65
    s_waitcnt vmcnt(10) lgkmcnt(11)
    v_dot2_f32_bf16 v120, v144, v72, v120
    v_dot2_f32_bf16 v121, v144, v73, v121
    v_dot2_f32_bf16 v122, v145, v72, v122
    v_dot2_f32_bf16 v123, v145, v73, v123
    v_dot2_f32_bf16 v124, v146, v72, v124
    v_dot2_f32_bf16 v125, v146, v73, v125
    v_dot2_f32_bf16 v126, v147, v72, v126
    v_dot2_f32_bf16 v127, v147, v73, v127
    buffer_load_dwordx4 v[188:191], v10, s[48:51], s66 offen
    s_add_u32 s66, s66, 5376
    s_nop 0
    s_waitcnt vmcnt(10)
    v_dot2_f32_bf16 v120, v148, v74, v120
    v_dot2_f32_bf16 v121, v148, v75, v121
    v_dot2_f32_bf16 v122, v149, v74, v122
    v_dot2_f32_bf16 v123, v149, v75, v123
    v_dot2_f32_bf16 v124, v150, v74, v124
    v_dot2_f32_bf16 v125, v150, v75, v125
    v_dot2_f32_bf16 v126, v151, v74, v126
    v_dot2_f32_bf16 v127, v151, v75, v127
    buffer_load_dwordx4 v[192:195], v10, s[48:51], s66 offen
    s_add_u32 s66, s66, 5376
    s_waitcnt lgkmcnt(0)
    s_mul_i32 s61, s63, 0x9E3779B1
    s_lshr_b32 s61, s61, 4
    s_add_u32 s61, s61, s63
    s_add_u32 s61, s61, 0x3C6EF372
    s_bitset0_b32 s61, 31
    v_mov_b32_e64 v2, s61
    s_cmp_eq_u32 s57, 124
    s_cselect_b32 s64, 4096, 1073741824
    v_lshrrev_b32_e64 v17, 4, v1
    v_lshl_add_u32 v17, v17, 25, v14
    v_bfe_u32 v18, v1, 3, 1
    v_mul_u32_u24 v18, 128, v18
    v_add_u32 v17, v17, v18
    v_mov_b32 v20, v2
    buffer_store_dwordx4 v[20:23], v17, s[24:27], s64 offen sc0 sc1
    s_nop 0
    s_waitcnt vmcnt(11)
    v_dot2_f32_bf16 v120, v152, v76, v120
    v_dot2_f32_bf16 v121, v152, v77, v121
    v_dot2_f32_bf16 v122, v153, v76, v122
    v_dot2_f32_bf16 v123, v153, v77, v123
    v_dot2_f32_bf16 v124, v154, v76, v124
    v_dot2_f32_bf16 v125, v154, v77, v125
    v_dot2_f32_bf16 v126, v155, v76, v126
    v_dot2_f32_bf16 v127, v155, v77, v127
    buffer_load_dwordx4 v[196:199], v10, s[48:51], s66 offen
    s_add_u32 s66, s66, 5376
    s_nop 0
    s_waitcnt vmcnt(11)
    v_dot2_f32_bf16 v120, v156, v78, v120
    v_dot2_f32_bf16 v121, v156, v79, v121
    v_dot2_f32_bf16 v122, v157, v78, v122
    v_dot2_f32_bf16 v123, v157, v79, v123
    v_dot2_f32_bf16 v124, v158, v78, v124
    v_dot2_f32_bf16 v125, v158, v79, v125
    v_dot2_f32_bf16 v126, v159, v78, v126
    v_dot2_f32_bf16 v127, v159, v79, v127
    buffer_load_dwordx4 v[200:203], v10, s[48:51], s66 offen
    s_add_u32 s66, s66, 5376
    s_nop 0
    s_waitcnt vmcnt(11)
    v_dot2_f32_bf16 v120, v160, v80, v120
    v_dot2_f32_bf16 v121, v160, v81, v121
    v_dot2_f32_bf16 v122, v161, v80, v122
    v_dot2_f32_bf16 v123, v161, v81, v123
    v_dot2_f32_bf16 v124, v162, v80, v124
    v_dot2_f32_bf16 v125, v162, v81, v125
    v_dot2_f32_bf16 v126, v163, v80, v126
    v_dot2_f32_bf16 v127, v163, v81, v127
    buffer_load_dwordx4 v[204:207], v10, s[48:51], s66 offen
    s_add_u32 s66, s66, 5376
    s_nop 0
    s_waitcnt vmcnt(11)
    v_dot2_f32_bf16 v120, v164, v82, v120
    v_dot2_f32_bf16 v121, v164, v83, v121
    v_dot2_f32_bf16 v122, v165, v82, v122
    v_dot2_f32_bf16 v123, v165, v83, v123
    v_dot2_f32_bf16 v124, v166, v82, v124
    v_dot2_f32_bf16 v125, v166, v83, v125
    v_dot2_f32_bf16 v126, v167, v82, v126
    v_dot2_f32_bf16 v127, v167, v83, v127
    buffer_load_dwordx4 v[208:211], v10, s[48:51], s66 offen
    s_add_u32 s66, s66, 5376
    s_nop 0
    s_waitcnt vmcnt(11)
    v_dot2_f32_bf16 v120, v168, v84, v120
    v_dot2_f32_bf16 v121, v168, v85, v121
    v_dot2_f32_bf16 v122, v169, v84, v122
    v_dot2_f32_bf16 v123, v169, v85, v123
    v_dot2_f32_bf16 v124, v170, v84, v124
    v_dot2_f32_bf16 v125, v170, v85, v125
    v_dot2_f32_bf16 v126, v171, v84, v126
    v_dot2_f32_bf16 v127, v171, v85, v127
    buffer_load_dwordx4 v[212:215], v10, s[48:51], s66 offen
    s_add_u32 s66, s66, 5376
    s_nop 0
    s_waitcnt vmcnt(11)
    v_dot2_f32_bf16 v120, v172, v86, v120
    v_dot2_f32_bf16 v121, v172, v87, v121
    v_dot2_f32_bf16 v122, v173, v86, v122
    v_dot2_f32_bf16 v123, v173, v87, v123
    v_dot2_f32_bf16 v124, v174, v86, v124
    v_dot2_f32_bf16 v125, v174, v87, v125
    v_dot2_f32_bf16 v126, v175, v86, v126
    v_dot2_f32_bf16 v127, v175, v87, v127
    buffer_load_dwordx4 v[216:219], v10, s[48:51], s66 offen
    s_add_u32 s66, s66, 5376
    s_nop 0
    s_waitcnt vmcnt(11)
    v_dot2_f32_bf16 v120, v176, v88, v120
    v_dot2_f32_bf16 v121, v176, v89, v121
    v_dot2_f32_bf16 v122, v177, v88, v122
    v_dot2_f32_bf16 v123, v177, v89, v123
    v_dot2_f32_bf16 v124, v178, v88, v124
    v_dot2_f32_bf16 v125, v178, v89, v125
    v_dot2_f32_bf16 v126, v179, v88, v126
    v_dot2_f32_bf16 v127, v179, v89, v127
    buffer_load_dwordx4 v[220:223], v10, s[48:51], s66 offen
    s_add_u32 s66, s66, 5376
    s_nop 0
    s_waitcnt vmcnt(11)
    v_dot2_f32_bf16 v120, v180, v90, v120
    v_dot2_f32_bf16 v121, v180, v91, v121
    v_dot2_f32_bf16 v122, v181, v90, v122
    v_dot2_f32_bf16 v123, v181, v91, v123
    v_dot2_f32_bf16 v124, v182, v90, v124
    v_dot2_f32_bf16 v125, v182, v91, v125
    v_dot2_f32_bf16 v126, v183, v90, v126
    v_dot2_f32_bf16 v127, v183, v91, v127
    buffer_load_dwordx4 v[224:227], v10, s[48:51], s66 offen
    s_add_u32 s66, s66, 5376
    s_nop 0
    s_waitcnt vmcnt(11)
    v_dot2_f32_bf16 v120, v184, v92, v120
    v_dot2_f32_bf16 v121, v184, v93, v121
    v_dot2_f32_bf16 v122, v185, v92, v122
    v_dot2_f32_bf16 v123, v185, v93, v123
    v_dot2_f32_bf16 v124, v186, v92, v124
    v_dot2_f32_bf16 v125, v186, v93, v125
    v_dot2_f32_bf16 v126, v187, v92, v126
    v_dot2_f32_bf16 v127, v187, v93, v127
    buffer_load_dwordx4 v[228:231], v10, s[48:51], s66 offen
    s_add_u32 s66, s66, 5376
    s_nop 0
    s_waitcnt vmcnt(11)
    v_dot2_f32_bf16 v120, v188, v94, v120
    v_dot2_f32_bf16 v121, v188, v95, v121
    v_dot2_f32_bf16 v122, v189, v94, v122
    v_dot2_f32_bf16 v123, v189, v95, v123
    v_dot2_f32_bf16 v124, v190, v94, v124
    v_dot2_f32_bf16 v125, v190, v95, v125
    v_dot2_f32_bf16 v126, v191, v94, v126
    v_dot2_f32_bf16 v127, v191, v95, v127
    buffer_load_dwordx4 v[232:235], v10, s[48:51], s66 offen
    s_add_u32 s66, s66, 5376
    s_nop 0
    s_waitcnt vmcnt(11)
    v_dot2_f32_bf16 v120, v192, v96, v120
    v_dot2_f32_bf16 v121, v192, v97, v121
    v_dot2_f32_bf16 v122, v193, v96, v122
    v_dot2_f32_bf16 v123, v193, v97, v123
    v_dot2_f32_bf16 v124, v194, v96, v124
    v_dot2_f32_bf16 v125, v194, v97, v125
    v_dot2_f32_bf16 v126, v195, v96, v126
    v_dot2_f32_bf16 v127, v195, v97, v127
    buffer_load_dwordx4 v[236:239], v10, s[48:51], s66 offen
    s_add_u32 s66, s66, 5376
    s_nop 0
    s_waitcnt vmcnt(10)
    v_dot2_f32_bf16 v120, v196, v98, v120
    v_dot2_f32_bf16 v121, v196, v99, v121
    v_dot2_f32_bf16 v122, v197, v98, v122
    v_dot2_f32_bf16 v123, v197, v99, v123
    v_dot2_f32_bf16 v124, v198, v98, v124
    v_dot2_f32_bf16 v125, v198, v99, v125
    v_dot2_f32_bf16 v126, v199, v98, v126
    v_dot2_f32_bf16 v127, v199, v99, v127
    s_cmp_eq_u32 s60, 0
    s_cbranch_scc0 L_w0_35
    s_mov_b32 s36, 0
    s_atomic_add s36, s[24:25], 4096 glc
    s_mov_b32 s37, 0
    s_atomic_add s37, s[24:25], 4352 glc
L_w0_35:
    s_nop 0
    s_waitcnt vmcnt(9)
    v_dot2_f32_bf16 v120, v200, v100, v120
    v_dot2_f32_bf16 v121, v200, v101, v121
    v_dot2_f32_bf16 v122, v201, v100, v122
    v_dot2_f32_bf16 v123, v201, v101, v123
    v_dot2_f32_bf16 v124, v202, v100, v124
    v_dot2_f32_bf16 v125, v202, v101, v125
    v_dot2_f32_bf16 v126, v203, v100, v126
    v_dot2_f32_bf16 v127, v203, v101, v127
    s_nop 0
    s_waitcnt vmcnt(8)
    v_dot2_f32_bf16 v120, v204, v102, v120
    v_dot2_f32_bf16 v121, v204, v103, v121
    v_dot2_f32_bf16 v122, v205, v102, v122
    v_dot2_f32_bf16 v123, v205, v103, v123
    v_dot2_f32_bf16 v124, v206, v102, v124
    v_dot2_f32_bf16 v125, v206, v103, v125
    v_dot2_f32_bf16 v126, v207, v102, v126
    v_dot2_f32_bf16 v127, v207, v103, v127
    s_add_u32 m0, s6, 0
    s_mov_b32 s67, 0
    buffer_load_dwordx4 v3, s[16:19], s67 offen offset:0 lds
    s_nop 0
    s_waitcnt vmcnt(8)
    v_dot2_f32_bf16 v120, v208, v104, v120
    v_dot2_f32_bf16 v121, v208, v105, v121
    v_dot2_f32_bf16 v122, v209, v104, v122
    v_dot2_f32_bf16 v123, v209, v105, v123
    v_dot2_f32_bf16 v124, v210, v104, v124
    v_dot2_f32_bf16 v125, v210, v105, v125
    v_dot2_f32_bf16 v126, v211, v104, v126
    v_dot2_f32_bf16 v127, v211, v105, v127
    s_add_u32 m0, s6, 128
    s_mov_b32 s67, 0
    buffer_load_dwordx4 v3, s[16:19], s67 offen offset:896 lds
    s_waitcnt vmcnt(8)
    v_dot2_f32_bf16 v120, v212, v106, v120
    v_dot2_f32_bf16 v121, v212, v107, v121
    v_dot2_f32_bf16 v122, v213, v106, v122
    v_dot2_f32_bf16 v123, v213, v107, v123
    v_dot2_f32_bf16 v124, v214, v106, v124
    v_dot2_f32_bf16 v125, v214, v107, v125
    v_dot2_f32_bf16 v126, v215, v106, v126
    v_dot2_f32_bf16 v127, v215, v107, v127
    s_add_u32 m0, s6, 256
    s_mov_b32 s67, 0
    buffer_load_dwordx4 v3, s[16:19], s67 offen offset:1792 lds
    s_waitcnt vmcnt(8)
    v_dot2_f32_bf16 v120, v216, v108, v120
    v_dot2_f32_bf16 v121, v216, v109, v121
    v_dot2_f32_bf16 v122, v217, v108, v122
    v_dot2_f32_bf16 v123, v217, v109, v123
    v_dot2_f32_bf16 v124, v218, v108, v124
    v_dot2_f32_bf16 v125, v218, v109, v125
    v_dot2_f32_bf16 v126, v219, v108, v126
    v_dot2_f32_bf16 v127, v219, v109, v127
    s_add_u32 m0, s6, 384
    s_mov_b32 s67, 0
    buffer_load_dwordx4 v3, s[16:19], s67 offen offset:2688 lds
    s_waitcnt vmcnt(8)
    v_dot2_f32_bf16 v120, v220, v110, v120
    v_dot2_f32_bf16 v121, v220, v111, v121
    v_dot2_f32_bf16 v122, v221, v110, v122
    v_dot2_f32_bf16 v123, v221, v111, v123
    v_dot2_f32_bf16 v124, v222, v110, v124
    v_dot2_f32_bf16 v125, v222, v111, v125
    v_dot2_f32_bf16 v126, v223, v110, v126
    v_dot2_f32_bf16 v127, v223, v111, v127
    s_add_u32 m0, s6, 4096
    s_mov_b32 s67, 458752
    buffer_load_dwordx4 v3, s[16:19], s67 offen offset:0 lds
    s_nop 0
    s_waitcnt vmcnt(8)
    v_dot2_f32_bf16 v120, v224, v112, v120
    v_dot2_f32_bf16 v121, v224, v113, v121
    v_dot2_f32_bf16 v122, v225, v112, v122
    v_dot2_f32_bf16 v123, v225, v113, v123
    v_dot2_f32_bf16 v124, v226, v112, v124
    v_dot2_f32_bf16 v125, v226, v113, v125
    v_dot2_f32_bf16 v126, v227, v112, v126
    v_dot2_f32_bf16 v127, v227, v113, v127
    s_add_u32 m0, s6, 4224
    s_mov_b32 s67, 458752
    buffer_load_dwordx4 v3, s[16:19], s67 offen offset:896 lds
    s_nop 0
    s_waitcnt vmcnt(8)
    v_dot2_f32_bf16 v120, v228, v114, v120
    v_dot2_f32_bf16 v121, v228, v115, v121
    v_dot2_f32_bf16 v122, v229, v114, v122
    v_dot2_f32_bf16 v123, v229, v115, v123
    v_dot2_f32_bf16 v124, v230, v114, v124
    v_dot2_f32_bf16 v125, v230, v115, v125
    v_dot2_f32_bf16 v126, v231, v114, v126
    v_dot2_f32_bf16 v127, v231, v115, v127
    s_add_u32 m0, s6, 4352
    s_mov_b32 s67, 458752
    buffer_load_dwordx4 v3, s[16:19], s67 offen offset:1792 lds
    s_nop 0
    s_waitcnt vmcnt(8)
    v_dot2_f32_bf16 v120, v232, v116, v120
    v_dot2_f32_bf16 v121, v232, v117, v121
    v_dot2_f32_bf16 v122, v233, v116, v122
    v_dot2_f32_bf16 v123, v233, v117, v123
    v_dot2_f32_bf16 v124, v234, v116, v124
    v_dot2_f32_bf16 v125, v234, v117, v125
    v_dot2_f32_bf16 v126, v235, v116, v126
    v_dot2_f32_bf16 v127, v235, v117, v127
    s_add_u32 m0, s6, 4480
    s_mov_b32 s67, 458752
    buffer_load_dwordx4 v3, s[16:19], s67 offen offset:2688 lds
    s_nop 0
    s_waitcnt vmcnt(8)
    v_dot2_f32_bf16 v120, v236, v118, v120
    v_dot2_f32_bf16 v121, v236, v119, v121
    v_dot2_f32_bf16 v122, v237, v118, v122
    v_dot2_f32_bf16 v123, v237, v119, v123
    v_dot2_f32_bf16 v124, v238, v118, v124
    v_dot2_f32_bf16 v125, v238, v119, v125
    v_dot2_f32_bf16 v126, v239, v118, v126
    v_dot2_f32_bf16 v127, v239, v119, v127
    v_lshlrev_b32_e64 v12, 9, v9
    v_lshl_add_u32 v12, v11, 5, v12
    ds_write_b128 v12, v[120:123] offset:13568
    ds_write_b128 v12, v[124:127] offset:13584
    ds_read_b32 v15, v14
    ds_read_b32 v15, v14
    s_waitcnt lgkmcnt(2)
    s_barrier
    v_and_b32 v12, 31, v1
    v_lshlrev_b32 v12, 4, v12
    v_lshrrev_b32_e64 v13, 5, v1
    v_lshl_add_u32 v13, v13, 12, v12
    ds_read_b128 v[64:67], v13 offset:13568
    ds_read_b128 v[68:71], v13 offset:14080
    ds_read_b128 v[72:75], v13 offset:14592
    ds_read_b128 v[76:79], v13 offset:15104
    ds_read_b128 v[80:83], v13 offset:15616
    ds_read_b128 v[84:87], v13 offset:16128
    ds_read_b128 v[88:91], v13 offset:16640
    ds_read_b128 v[92:95], v13 offset:17152
    s_lshl_b32 s64, s56, 5
    v_and_b32 v112, 31, v1
    v_add_u32_e64 v112, s64, v112
    v_subrev_u32 v113, 112, v112
    v_subrev_u32 v114, 448, v112
    v_min_u32_e64 v113, v113, v114
    v_cmp_gt_u32 vcc, 112, v113
    s_nop 1
    v_cndmask_b32_e64 v113, 0, 1.0, vcc
    s_waitcnt lgkmcnt(6)
    v_pk_add_f32 v[64:65], v[64:65], v[68:69]
    v_pk_add_f32 v[66:67], v[66:67], v[70:71]
    s_waitcnt lgkmcnt(5)
    v_pk_add_f32 v[64:65], v[64:65], v[72:73]
    v_pk_add_f32 v[66:67], v[66:67], v[74:75]
    s_waitcnt lgkmcnt(4)
    v_pk_add_f32 v[64:65], v[64:65], v[76:77]
    v_pk_add_f32 v[66:67], v[66:67], v[78:79]
    s_waitcnt lgkmcnt(3)
    v_pk_add_f32 v[64:65], v[64:65], v[80:81]
    v_pk_add_f32 v[66:67], v[66:67], v[82:83]
    s_waitcnt lgkmcnt(2)
    v_pk_add_f32 v[64:65], v[64:65], v[84:85]
    v_pk_add_f32 v[66:67], v[66:67], v[86:87]
    s_waitcnt lgkmcnt(1)
    v_pk_add_f32 v[64:65], v[64:65], v[88:89]
    v_pk_add_f32 v[66:67], v[66:67], v[90:91]
    s_waitcnt lgkmcnt(0)
    v_pk_add_f32 v[64:65], v[64:65], v[92:93]
    v_pk_add_f32 v[66:67], v[66:67], v[94:95]
    v_mov_b32 v68, v64
    v_mov_b32 v69, v65
    v_mov_b32 v70, v66
    v_mov_b32 v71, v67
    v_permlane32_swap_b32 v68, v64
    v_permlane32_swap_b32 v69, v65
    v_permlane32_swap_b32 v70, v66
    v_permlane32_swap_b32 v71, v67
    v_add_f32 v64, v64, v68
    v_add_f32 v65, v65, v69
    v_add_f32 v66, v66, v70
    v_add_f32 v67, v67, v71
    v_cvt_pk_bf16_f32 v116, v64, v65
    v_cvt_pk_bf16_f32 v117, v66, v67
    v_lshlrev_b32 v64, 16, v116
    v_and_b32 v65, s71, v116
    v_lshlrev_b32 v66, 16, v117
    v_and_b32 v67, s71, v117
    v_add_f32 v64, v64, v113
    v_add_f32 v65, v65, v113
    v_add_f32 v66, v66, v113
    v_add_f32 v67, v67, v113
    v_cvt_pk_bf16_f32 v116, v64, v65
    v_cvt_pk_bf16_f32 v117, v66, v67
    v_lshrrev_b32 v12, 1, v12
    s_lshl_b32 s64, s56, 8
    s_add_u32 s64, s64, 720896
    s_cmp_eq_u32 s60, 0
    s_cselect_b32 s64, s64, 1073741824
    buffer_store_dwordx2 v[116:117], v12, s[24:27], s64 offen sc0 sc1
    s_lshl_b32 s64, s60, 5
    s_lshr_b32 s65, s57, 2
    s_add_u32 s64, s64, s65
    s_mul_i32 s64, s64, 512
    s_add_u32 s64, s64, 19922944
    buffer_store_dwordx4 v[20:23], v17, s[24:27], s64 offen sc0 sc1
    s_add_u32 s64, s64, 65536
    s_cmp_eq_u32 s60, 0
    s_cselect_b32 s64, s64, 1073741824
    buffer_store_dwordx4 v[20:23], v17, s[24:27], s64 offen sc0 sc1
    s_waitcnt vmcnt(7)
    ds_read_b128 v[80:83], v252 offset:0
    ds_read_b128 v[84:87], v252 offset:1024
    ds_read_b128 v[88:91], v252 offset:2048
    ds_read_b128 v[92:95], v252 offset:3072
    s_nop 0
    s_waitcnt lgkmcnt(0)
    v_dot2_f32_bf16 v244, v80, s9, 0
    v_dot2_f32_bf16 v248, v80, v80, 0
    v_dot2_f32_bf16 v245, v84, s9, 0
    v_dot2_f32_bf16 v249, v84, v84, 0
    v_dot2_f32_bf16 v246, v88, s9, 0
    v_dot2_f32_bf16 v250, v88, v88, 0
    v_dot2_f32_bf16 v247, v92, s9, 0
    v_dot2_f32_bf16 v251, v92, v92, 0
    v_dot2_f32_bf16 v244, v81, s9, v244
    v_dot2_f32_bf16 v248, v81, v81, v248
    v_dot2_f32_bf16 v245, v85, s9, v245
    v_dot2_f32_bf16 v249, v85, v85, v249
    v_dot2_f32_bf16 v246, v89, s9, v246
    v_dot2_f32_bf16 v250, v89, v89, v250
    v_dot2_f32_bf16 v247, v93, s9, v247
    v_dot2_f32_bf16 v251, v93, v93, v251
    v_dot2_f32_bf16 v244, v82, s9, v244
    v_dot2_f32_bf16 v248, v82, v82, v248
    v_dot2_f32_bf16 v245, v86, s9, v245
    v_dot2_f32_bf16 v249, v86, v86, v249
    v_dot2_f32_bf16 v246, v90, s9, v246
    v_dot2_f32_bf16 v250, v90, v90, v250
    v_dot2_f32_bf16 v247, v94, s9, v247
    v_dot2_f32_bf16 v251, v94, v94, v251
    v_dot2_f32_bf16 v244, v83, s9, v244
    v_dot2_f32_bf16 v248, v83, v83, v248
    v_dot2_f32_bf16 v245, v87, s9, v245
    v_dot2_f32_bf16 v249, v87, v87, v249
    v_dot2_f32_bf16 v246, v91, s9, v246
    v_dot2_f32_bf16 v250, v91, v91, v250
    v_dot2_f32_bf16 v247, v95, s9, v247
    v_dot2_f32_bf16 v251, v95, v95, v251
    v_add_f32_dpp v244, v244, v244 row_ror:8 row_mask:0xf bank_mask:0x3
    v_add_f32_dpp v248, v248, v248 row_ror:8 row_mask:0xf bank_mask:0x3
    v_add_f32_dpp v246, v246, v246 row_ror:8 row_mask:0xf bank_mask:0x3
    v_add_f32_dpp v250, v250, v250 row_ror:8 row_mask:0xf bank_mask:0x3
    v_add_f32_dpp v244, v245, v245 row_ror:8 row_mask:0xf bank_mask:0xc
    v_add_f32_dpp v248, v249, v249 row_ror:8 row_mask:0xf bank_mask:0xc
    v_add_f32_dpp v246, v247, v247 row_ror:8 row_mask:0xf bank_mask:0xc
    v_add_f32_dpp v250, v251, v251 row_ror:8 row_mask:0xf bank_mask:0xc
    v_add_f32_dpp v244, v244, v244 row_half_mirror row_mask:0xf bank_mask:0x5
    v_add_f32_dpp v248, v248, v248 row_half_mirror row_mask:0xf bank_mask:0x5
    s_nop 0
    v_add_f32_dpp v244, v246, v246 row_half_mirror row_mask:0xf bank_mask:0xa
    v_add_f32_dpp v248, v250, v250 row_half_mirror row_mask:0xf bank_mask:0xa
    s_nop 1
    v_permlane32_swap_b32 v244, v248
    v_add_f32 v244, v244, v248
    s_nop 1
    v_add_f32_dpp v244, v244, v244 quad_perm:[1,0,3,2] row_mask:0xf bank_mask:0xf
    s_nop 1
    v_add_f32_dpp v244, v244, v244 quad_perm:[2,3,0,1] row_mask:0xf bank_mask:0xf
    v_mov_b32 v245, v244
    s_nop 1
    v_permlane16_swap_b32 v245, v244
    v_add_f32 v244, v244, v245
    v_mul_f32 v244, s10, v244
    v_mov_b32 v245, v244
    s_nop 1
    v_permlane32_swap_b32 v245, v244
    v_fma_f32 v244, -v245, v245, v244
    v_max_f32 v244, 0, v244
    v_add_f32 v244, s11, v244
    v_rsq_f32 v244, v244
    s_nop 0
    v_mul_f32_e64 v245, -v245, v244
    v_readlane_b32 s28, v244, 0
    v_readlane_b32 s30, v244, 8
    v_readlane_b32 s32, v244, 4
    v_readlane_b32 s34, v244, 12
    v_readlane_b32 s29, v245, 0
    v_readlane_b32 s31, v245, 8
    v_readlane_b32 s33, v245, 4
    v_readlane_b32 s35, v245, 12
    s_waitcnt vmcnt(3)
    ds_read_b128 v[144:147], v252 offset:4096
    ds_read_b128 v[148:151], v252 offset:5120
    ds_read_b128 v[152:155], v252 offset:6144
    ds_read_b128 v[156:159], v252 offset:7168
    v_lshlrev_b32 v48, 16, v80
    v_and_b32 v49, s71, v80
    v_lshlrev_b32 v50, 16, v81
    v_and_b32 v51, s71, v81
    v_lshlrev_b32 v52, 16, v82
    v_and_b32 v53, s71, v82
    v_lshlrev_b32 v54, 16, v83
    v_and_b32 v55, s71, v83
    v_lshlrev_b32 v56, 16, v84
    v_and_b32 v57, s71, v84
    v_lshlrev_b32 v58, 16, v85
    v_and_b32 v59, s71, v85
    v_lshlrev_b32 v60, 16, v86
    v_and_b32 v61, s71, v86
    v_lshlrev_b32 v62, 16, v87
    v_and_b32 v63, s71, v87
    v_lshlrev_b32 v64, 16, v88
    v_and_b32 v65, s71, v88
    v_lshlrev_b32 v66, 16, v89
    v_and_b32 v67, s71, v89
    v_lshlrev_b32 v68, 16, v90
    v_and_b32 v69, s71, v90
    v_lshlrev_b32 v70, 16, v91
    v_and_b32 v71, s71, v91
    v_lshlrev_b32 v72, 16, v92
    v_and_b32 v73, s71, v92
    v_lshlrev_b32 v74, 16, v93
    v_and_b32 v75, s71, v93
    v_lshlrev_b32 v76, 16, v94
    v_and_b32 v77, s71, v94
    v_lshlrev_b32 v78, 16, v95
    v_and_b32_e64 v79, s71, v95
    v_pk_fma_f32 v[80:81], v[48:49], s[28:29], s[28:29] op_sel:[0,0,1] op_sel_hi:[1,0,1]
    v_pk_fma_f32 v[82:83], v[50:51], s[28:29], s[28:29] op_sel:[0,0,1] op_sel_hi:[1,0,1]
    v_pk_fma_f32 v[84:85], v[52:53], s[28:29], s[28:29] op_sel:[0,0,1] op_sel_hi:[1,0,1]
    v_pk_fma_f32 v[86:87], v[54:55], s[28:29], s[28:29] op_sel:[0,0,1] op_sel_hi:[1,0,1]
    v_pk_fma_f32 v[88:89], v[56:57], s[30:31], s[30:31] op_sel:[0,0,1] op_sel_hi:[1,0,1]
    v_pk_fma_f32 v[90:91], v[58:59], s[30:31], s[30:31] op_sel:[0,0,1] op_sel_hi:[1,0,1]
    v_pk_fma_f32 v[92:93], v[60:61], s[30:31], s[30:31] op_sel:[0,0,1] op_sel_hi:[1,0,1]
    v_pk_fma_f32 v[94:95], v[62:63], s[30:31], s[30:31] op_sel:[0,0,1] op_sel_hi:[1,0,1]
    v_pk_fma_f32 v[96:97], v[64:65], s[32:33], s[32:33] op_sel:[0,0,1] op_sel_hi:[1,0,1]
    v_pk_fma_f32 v[98:99], v[66:67], s[32:33], s[32:33] op_sel:[0,0,1] op_sel_hi:[1,0,1]
    v_pk_fma_f32 v[100:101], v[68:69], s[32:33], s[32:33] op_sel:[0,0,1] op_sel_hi:[1,0,1]
    v_pk_fma_f32 v[102:103], v[70:71], s[32:33], s[32:33] op_sel:[0,0,1] op_sel_hi:[1,0,1]
    v_pk_fma_f32 v[104:105], v[72:73], s[34:35], s[34:35] op_sel:[0,0,1] op_sel_hi:[1,0,1]
    v_pk_fma_f32 v[106:107], v[74:75], s[34:35], s[34:35] op_sel:[0,0,1] op_sel_hi:[1,0,1]
    v_pk_fma_f32 v[108:109], v[76:77], s[34:35], s[34:35] op_sel:[0,0,1] op_sel_hi:[1,0,1]
    v_pk_fma_f32 v[110:111], v[78:79], s[34:35], s[34:35] op_sel:[0,0,1] op_sel_hi:[1,0,1]
    s_and_b32 s38, s58, 1
    s_mul_i32 s38, s38, 256
    s_add_u32 s38, s38, 4096
    s_add_u32 s39, s61, 32
    s_waitcnt vmcnt(0) lgkmcnt(0)
    s_cmp_eq_u32 s60, 0
    s_cbranch_scc0 L_w0_40
    s_sub_u32 s36, s36, s61
    s_cmp_le_u32 s36, 32
    s_cbranch_scc0 L_retry_37
L_ok_36:
    s_sub_u32 s37, s37, s61
    s_cmp_le_u32 s37, 32
    s_cbranch_scc0 L_retry_39
L_ok_38:
    s_atomic_add s3, s[24:25], 4096
    s_atomic_add s3, s[24:25], 4352
    s_mov_b32 s39, 0
    s_atomic_add s39, s[24:25], s38 glc
L_w0_40:
    s_add_u32 s36, s61, 32
    s_add_u32 s76, s61, 16
    s_nop 0
    s_mov_b32 s77, s76
    v_dot2_f32_bf16 v244, v144, s9, 0
    v_dot2_f32_bf16 v248, v144, v144, 0
    v_dot2_f32_bf16 v245, v148, s9, 0
    v_dot2_f32_bf16 v249, v148, v148, 0
    v_dot2_f32_bf16 v246, v152, s9, 0
    v_dot2_f32_bf16 v250, v152, v152, 0
    v_dot2_f32_bf16 v247, v156, s9, 0
    v_dot2_f32_bf16 v251, v156, v156, 0
    v_dot2_f32_bf16 v244, v145, s9, v244
    v_dot2_f32_bf16 v248, v145, v145, v248
    v_dot2_f32_bf16 v245, v149, s9, v245
    v_dot2_f32_bf16 v249, v149, v149, v249
    s_add_u32 m0, s6, 8192
    s_mov_b32 s67, 917504
    buffer_load_dwordx4 v3, s[16:19], s67 offen offset:0 lds
    v_dot2_f32_bf16 v246, v153, s9, v246
    v_dot2_f32_bf16 v250, v153, v153, v250
    v_dot2_f32_bf16 v247, v157, s9, v247
    v_dot2_f32_bf16 v251, v157, v157, v251
    v_dot2_f32_bf16 v244, v146, s9, v244
    v_dot2_f32_bf16 v248, v146, v146, v248
    v_dot2_f32_bf16 v245, v150, s9, v245
    v_dot2_f32_bf16 v249, v150, v150, v249
    v_dot2_f32_bf16 v246, v154, s9, v246
    v_dot2_f32_bf16 v250, v154, v154, v250
    v_dot2_f32_bf16 v247, v158, s9, v247
    v_dot2_f32_bf16 v251, v158, v158, v251
    v_dot2_f32_bf16 v244, v147, s9, v244
    s_add_u32 m0, s6, 8320
    s_mov_b32 s67, 917504
    buffer_load_dwordx4 v3, s[16:19], s67 offen offset:896 lds
    v_dot2_f32_bf16 v248, v147, v147, v248
    v_dot2_f32_bf16 v245, v151, s9, v245
    v_dot2_f32_bf16 v249, v151, v151, v249
    v_dot2_f32_bf16 v246, v155, s9, v246
    v_dot2_f32_bf16 v250, v155, v155, v250
    v_dot2_f32_bf16 v247, v159, s9, v247
    v_dot2_f32_bf16 v251, v159, v159, v251
    v_add_f32_dpp v244, v244, v244 row_ror:8 row_mask:0xf bank_mask:0x3
    v_add_f32_dpp v248, v248, v248 row_ror:8 row_mask:0xf bank_mask:0x3
    v_add_f32_dpp v246, v246, v246 row_ror:8 row_mask:0xf bank_mask:0x3
    v_add_f32_dpp v250, v250, v250 row_ror:8 row_mask:0xf bank_mask:0x3
    v_add_f32_dpp v244, v245, v245 row_ror:8 row_mask:0xf bank_mask:0xc
    s_add_u32 m0, s6, 8448
    s_mov_b32 s67, 917504
    buffer_load_dwordx4 v3, s[16:19], s67 offen offset:1792 lds
    v_add_f32_dpp v248, v249, v249 row_ror:8 row_mask:0xf bank_mask:0xc
    v_add_f32_dpp v246, v247, v247 row_ror:8 row_mask:0xf bank_mask:0xc
    v_add_f32_dpp v250, v251, v251 row_ror:8 row_mask:0xf bank_mask:0xc
    v_add_f32_dpp v244, v244, v244 row_half_mirror row_mask:0xf bank_mask:0x5
    v_add_f32_dpp v248, v248, v248 row_half_mirror row_mask:0xf bank_mask:0x5
    s_nop 0
    v_add_f32_dpp v244, v246, v246 row_half_mirror row_mask:0xf bank_mask:0xa
    v_add_f32_dpp v248, v250, v250 row_half_mirror row_mask:0xf bank_mask:0xa
    s_nop 1
    v_permlane32_swap_b32 v244, v248
    v_add_f32 v244, v244, v248
    s_nop 1
    v_add_f32_dpp v244, v244, v244 quad_perm:[1,0,3,2] row_mask:0xf bank_mask:0xf
    s_nop 1
    v_add_f32_dpp v244, v244, v244 quad_perm:[2,3,0,1] row_mask:0xf bank_mask:0xf
    v_mov_b32 v245, v244
    s_nop 1
    v_permlane16_swap_b32 v245, v244
    v_add_f32 v244, v244, v245
    v_mul_f32 v244, s10, v244
    v_mov_b32 v245, v244
    s_nop 1
    v_permlane32_swap_b32 v245, v244
    v_fma_f32 v244, -v245, v245, v244
    v_max_f32 v244, 0, v244
    v_add_f32 v244, s11, v244
    v_rsq_f32 v244, v244
    s_nop 0
    v_mul_f32_e64 v245, -v245, v244
    v_readlane_b32 s28, v244, 0
    v_readlane_b32 s30, v244, 8
    s_add_u32 m0, s6, 8576
    s_mov_b32 s67, 917504
    buffer_load_dwordx4 v3, s[16:19], s67 offen offset:2688 lds
    v_readlane_b32 s32, v244, 4
    v_readlane_b32 s34, v244, 12
    v_readlane_b32 s29, v245, 0
    v_readlane_b32 s31, v245, 8
    v_readlane_b32 s33, v245, 4
    v_readlane_b32 s35, v245, 12
    v_lshlrev_b32 v112, 16, v144
    v_and_b32 v113, s71, v144
    v_lshlrev_b32 v114, 16, v145
    v_and_b32 v115, s71, v145
    v_lshlrev_b32 v116, 16, v146
    v_and_b32 v117, s71, v146
    s_add_u32 m0, s6, 12288
    s_mov_b32 s67, 1376256
    buffer_load_dwordx4 v3, s[16:19], s67 offen offset:0 lds
    v_lshlrev_b32 v118, 16, v147
    v_and_b32 v119, s71, v147
    v_lshlrev_b32 v120, 16, v148
    v_and_b32 v121, s71, v148
    v_lshlrev_b32 v122, 16, v149
    v_and_b32 v123, s71, v149
    v_lshlrev_b32 v124, 16, v150
    v_and_b32 v125, s71, v150
    v_lshlrev_b32 v126, 16, v151
    v_and_b32 v127, s71, v151
    v_lshlrev_b32 v128, 16, v152
    v_and_b32 v129, s71, v152
    v_lshlrev_b32_e64 v130, 16, v153
    s_add_u32 m0, s6, 12416
    s_mov_b32 s67, 1376256
    buffer_load_dwordx4 v3, s[16:19], s67 offen offset:896 lds
    v_and_b32 v131, s71, v153
    v_lshlrev_b32 v132, 16, v154
    v_and_b32 v133, s71, v154
    v_lshlrev_b32 v134, 16, v155
    v_and_b32 v135, s71, v155
    v_lshlrev_b32 v136, 16, v156
    v_and_b32 v137, s71, v156
    v_lshlrev_b32 v138, 16, v157
    v_and_b32 v139, s71, v157
    v_lshlrev_b32 v140, 16, v158
    v_and_b32 v141, s71, v158
    v_lshlrev_b32 v142, 16, v159
    s_add_u32 m0, s6, 12544
    s_mov_b32 s67, 1376256
    buffer_load_dwordx4 v3, s[16:19], s67 offen offset:1792 lds
    v_and_b32_e64 v143, s71, v159
    v_pk_fma_f32 v[144:145], v[112:113], s[28:29], s[28:29] op_sel:[0,0,1] op_sel_hi:[1,0,1]
    v_pk_fma_f32 v[146:147], v[114:115], s[28:29], s[28:29] op_sel:[0,0,1] op_sel_hi:[1,0,1]
    v_pk_fma_f32 v[148:149], v[116:117], s[28:29], s[28:29] op_sel:[0,0,1] op_sel_hi:[1,0,1]
    v_pk_fma_f32 v[150:151], v[118:119], s[28:29], s[28:29] op_sel:[0,0,1] op_sel_hi:[1,0,1]
    v_pk_fma_f32 v[152:153], v[120:121], s[30:31], s[30:31] op_sel:[0,0,1] op_sel_hi:[1,0,1]
    v_pk_fma_f32 v[154:155], v[122:123], s[30:31], s[30:31] op_sel:[0,0,1] op_sel_hi:[1,0,1]
    v_pk_fma_f32 v[156:157], v[124:125], s[30:31], s[30:31] op_sel:[0,0,1] op_sel_hi:[1,0,1]
    v_pk_fma_f32 v[158:159], v[126:127], s[30:31], s[30:31] op_sel:[0,0,1] op_sel_hi:[1,0,1]
    v_pk_fma_f32 v[160:161], v[128:129], s[32:33], s[32:33] op_sel:[0,0,1] op_sel_hi:[1,0,1]
    v_pk_fma_f32 v[162:163], v[130:131], s[32:33], s[32:33] op_sel:[0,0,1] op_sel_hi:[1,0,1]
    v_pk_fma_f32 v[164:165], v[132:133], s[32:33], s[32:33] op_sel:[0,0,1] op_sel_hi:[1,0,1]
    v_pk_fma_f32 v[166:167], v[134:135], s[32:33], s[32:33] op_sel:[0,0,1] op_sel_hi:[1,0,1]
    s_add_u32 m0, s6, 12672
    s_mov_b32 s67, 1376256
    buffer_load_dwordx4 v3, s[16:19], s67 offen offset:2688 lds
    v_pk_fma_f32 v[168:169], v[136:137], s[34:35], s[34:35] op_sel:[0,0,1] op_sel_hi:[1,0,1]
    v_pk_fma_f32 v[170:171], v[138:139], s[34:35], s[34:35] op_sel:[0,0,1] op_sel_hi:[1,0,1]
    v_pk_fma_f32 v[172:173], v[140:141], s[34:35], s[34:35] op_sel:[0,0,1] op_sel_hi:[1,0,1]
    v_pk_fma_f32 v[174:175], v[142:143], s[34:35], s[34:35] op_sel:[0,0,1] op_sel_hi:[1,0,1]
    s_waitcnt lgkmcnt(0)
    s_cmp_eq_u32 s39, s36
    s_cbranch_scc0 L_retry_42
L_ok_41:
    s_barrier
    s_mov_b32 s68, 720896
    buffer_load_dwordx4 v[176:179], v5, s[24:27], s68 offen offset:0 sc1
    buffer_load_dwordx4 v[180:183], v5, s[24:27], s68 offen offset:896 sc1
    buffer_load_dwordx4 v[184:187], v5, s[24:27], s68 offen offset:1792 sc1
    buffer_load_dwordx4 v[188:191], v5, s[24:27], s68 offen offset:2688 sc1
    buffer_load_dwordx4 v[192:195], v5, s[24:27], s68 offen offset:3584 sc1
    s_waitcnt vmcnt(9)
    ds_read_b128 v[208:211], v252 offset:8192
    ds_read_b128 v[212:215], v252 offset:9216
    ds_read_b128 v[216:219], v252 offset:10240
    ds_read_b128 v[220:223], v252 offset:11264
    s_waitcnt lgkmcnt(0)
    v_dot2_f32_bf16 v244, v208, s9, 0
    v_dot2_f32_bf16 v248, v208, v208, 0
    v_dot2_f32_bf16 v245, v212, s9, 0
    v_dot2_f32_bf16 v249, v212, v212, 0
    v_dot2_f32_bf16 v246, v216, s9, 0
    v_dot2_f32_bf16 v250, v216, v216, 0
    v_dot2_f32_bf16 v247, v220, s9, 0
    v_dot2_f32_bf16 v251, v220, v220, 0
    v_dot2_f32_bf16 v244, v209, s9, v244
    v_dot2_f32_bf16 v248, v209, v209, v248
    v_dot2_f32_bf16 v245, v213, s9, v245
    v_dot2_f32_bf16 v249, v213, v213, v249
    v_dot2_f32_bf16 v246, v217, s9, v246
    v_dot2_f32_bf16 v250, v217, v217, v250
    v_dot2_f32_bf16 v247, v221, s9, v247
    v_dot2_f32_bf16 v251, v221, v221, v251
    v_dot2_f32_bf16 v244, v210, s9, v244
    v_dot2_f32_bf16 v248, v210, v210, v248
    v_dot2_f32_bf16 v245, v214, s9, v245
    v_dot2_f32_bf16 v249, v214, v214, v249
    v_dot2_f32_bf16 v246, v218, s9, v246
    v_dot2_f32_bf16 v250, v218, v218, v250
    v_dot2_f32_bf16 v247, v222, s9, v247
    v_dot2_f32_bf16 v251, v222, v222, v251
    v_dot2_f32_bf16 v244, v211, s9, v244
    v_dot2_f32_bf16 v248, v211, v211, v248
    v_dot2_f32_bf16 v245, v215, s9, v245
    v_dot2_f32_bf16 v249, v215, v215, v249
    v_dot2_f32_bf16 v246, v219, s9, v246
    v_dot2_f32_bf16 v250, v219, v219, v250
    v_dot2_f32_bf16 v247, v223, s9, v247
    v_dot2_f32_bf16 v251, v223, v223, v251
    v_add_f32_dpp v244, v244, v244 row_ror:8 row_mask:0xf bank_mask:0x3
    v_add_f32_dpp v248, v248, v248 row_ror:8 row_mask:0xf bank_mask:0x3
    v_add_f32_dpp v246, v246, v246 row_ror:8 row_mask:0xf bank_mask:0x3
    v_add_f32_dpp v250, v250, v250 row_ror:8 row_mask:0xf bank_mask:0x3
    v_add_f32_dpp v244, v245, v245 row_ror:8 row_mask:0xf bank_mask:0xc
    v_add_f32_dpp v248, v249, v249 row_ror:8 row_mask:0xf bank_mask:0xc
    v_add_f32_dpp v246, v247, v247 row_ror:8 row_mask:0xf bank_mask:0xc
    v_add_f32_dpp v250, v251, v251 row_ror:8 row_mask:0xf bank_mask:0xc
    v_add_f32_dpp v244, v244, v244 row_half_mirror row_mask:0xf bank_mask:0x5
    v_add_f32_dpp v248, v248, v248 row_half_mirror row_mask:0xf bank_mask:0x5
    s_nop 0
    v_add_f32_dpp v244, v246, v246 row_half_mirror row_mask:0xf bank_mask:0xa
    v_add_f32_dpp v248, v250, v250 row_half_mirror row_mask:0xf bank_mask:0xa
    s_nop 1
    v_permlane32_swap_b32 v244, v248
    v_add_f32 v244, v244, v248
    s_nop 1
    v_add_f32_dpp v244, v244, v244 quad_perm:[1,0,3,2] row_mask:0xf bank_mask:0xf
    s_nop 1
    v_add_f32_dpp v244, v244, v244 quad_perm:[2,3,0,1] row_mask:0xf bank_mask:0xf
    v_mov_b32 v245, v244
    s_nop 1
    v_permlane16_swap_b32 v245, v244
    v_add_f32 v244, v244, v245
    v_mul_f32 v244, s10, v244
    v_mov_b32 v245, v244
    s_nop 1
    v_permlane32_swap_b32 v245, v244
    v_fma_f32 v244, -v245, v245, v244
    v_max_f32 v244, 0, v244
    v_add_f32 v244, s11, v244
    v_rsq_f32 v244, v244
    s_nop 0
    v_mul_f32_e64 v245, -v245, v244
    v_readlane_b32 s40, v244, 0
    v_readlane_b32 s42, v244, 8
    v_readlane_b32 s44, v244, 4
    v_readlane_b32 s46, v244, 12
    v_readlane_b32 s41, v245, 0
    v_readlane_b32 s43, v245, 8
    v_readlane_b32 s45, v245, 4
    v_readlane_b32 s47, v245, 12
    s_waitcnt vmcnt(4)
    v_lshlrev_b32 v24, 16, v176
    v_and_b32 v25, s71, v176
    v_lshlrev_b32 v26, 16, v177
    v_and_b32 v27, s71, v177
    v_lshlrev_b32 v28, 16, v178
    v_and_b32 v29, s71, v178
    v_lshlrev_b32 v30, 16, v179
    v_and_b32 v31, s71, v179
    s_waitcnt vmcnt(3)
    v_lshlrev_b32 v16, 16, v180
    v_and_b32 v17, s71, v180
    v_lshlrev_b32 v18, 16, v181
    v_and_b32 v19, s71, v181
    v_lshlrev_b32 v20, 16, v182
    v_and_b32 v21, s71, v182
    v_lshlrev_b32 v22, 16, v183
    v_and_b32 v23, s71, v183
    s_waitcnt vmcnt(2)
    v_lshlrev_b32 v6, 16, v184
    v_and_b32 v7, s71, v184
    v_lshlrev_b32 v8, 16, v185
    v_and_b32 v9, s71, v185
    v_lshlrev_b32 v10, 16, v186
    v_and_b32 v11, s71, v186
    v_lshlrev_b32 v12, 16, v187
    v_and_b32_e64 v13, s71, v187
    v_pk_mul_f32 v[16:17], v[16:17], v[6:7]
    v_pk_mul_f32 v[18:19], v[18:19], v[8:9]
    v_pk_mul_f32 v[20:21], v[20:21], v[10:11]
    v_pk_mul_f32 v[22:23], v[22:23], v[12:13]
    v_pk_mul_f32 v[24:25], v[24:25], v[6:7]
    v_pk_mul_f32 v[26:27], v[26:27], v[8:9]
    v_pk_mul_f32 v[28:29], v[28:29], v[10:11]
    v_pk_mul_f32 v[30:31], v[30:31], v[12:13]
    s_waitcnt vmcnt(1)
    v_lshlrev_b32 v40, 16, v188
    v_and_b32 v41, s71, v188
    v_lshlrev_b32 v42, 16, v189
    v_and_b32 v43, s71, v189
    v_lshlrev_b32 v44, 16, v190
    v_and_b32 v45, s71, v190
    v_lshlrev_b32 v46, 16, v191
    v_and_b32 v47, s71, v191
    s_waitcnt vmcnt(0)
    v_lshlrev_b32 v32, 16, v192
    v_and_b32 v33, s71, v192
    v_lshlrev_b32 v34, 16, v193
    v_and_b32 v35, s71, v193
    v_lshlrev_b32 v36, 16, v194
    v_and_b32 v37, s71, v194
    v_lshlrev_b32 v38, 16, v195
    v_and_b32 v39, s71, v195
    ds_read_b128 v[208:211], v252 offset:12288
    ds_read_b128 v[212:215], v252 offset:13312
    ds_read_b128 v[216:219], v252 offset:14336
    ds_read_b128 v[220:223], v252 offset:15360
    s_waitcnt lgkmcnt(0)
    s_add_u32 s7, s12, 0
    s_mov_b32 s20, 0
    s_atomic_add s20, s[24:25], s7 glc
    s_add_u32 s7, s13, 0
    s_mov_b32 s21, 0
    s_atomic_add s21, s[24:25], s7 glc
    s_add_u32 s7, s14, 0
    s_mov_b32 s22, 0
    s_atomic_add s22, s[24:25], s7 glc
    s_add_u32 s7, s15, 0
    s_nop 0
    s_mov_b32 s23, 0
    s_atomic_add s23, s[24:25], s7 glc
    v_pk_fma_f32 v[80:81], v[80:81], v[16:17], v[24:25]
    v_pk_fma_f32 v[82:83], v[82:83], v[18:19], v[26:27]
    v_pk_fma_f32 v[84:85], v[84:85], v[20:21], v[28:29]
    v_pk_fma_f32 v[86:87], v[86:87], v[22:23], v[30:31]
    v_pk_fma_f32 v[88:89], v[88:89], v[16:17], v[24:25]
    v_pk_fma_f32 v[90:91], v[90:91], v[18:19], v[26:27]
    v_pk_fma_f32 v[92:93], v[92:93], v[20:21], v[28:29]
    v_pk_fma_f32 v[94:95], v[94:95], v[22:23], v[30:31]
    v_pk_fma_f32 v[96:97], v[96:97], v[16:17], v[24:25]
    v_pk_fma_f32 v[98:99], v[98:99], v[18:19], v[26:27]
    v_pk_fma_f32 v[100:101], v[100:101], v[20:21], v[28:29]
    v_pk_fma_f32 v[102:103], v[102:103], v[22:23], v[30:31]
    v_pk_fma_f32 v[104:105], v[104:105], v[16:17], v[24:25]
    v_pk_fma_f32 v[106:107], v[106:107], v[18:19], v[26:27]
    v_pk_fma_f32 v[108:109], v[108:109], v[20:21], v[28:29]
    v_pk_fma_f32 v[110:111], v[110:111], v[22:23], v[30:31]
    v_pk_fma_f32 v[144:145], v[144:145], v[16:17], v[24:25]
    v_pk_fma_f32 v[146:147], v[146:147], v[18:19], v[26:27]
    v_pk_fma_f32 v[148:149], v[148:149], v[20:21], v[28:29]
    v_pk_fma_f32 v[150:151], v[150:151], v[22:23], v[30:31]
    v_pk_fma_f32 v[152:153], v[152:153], v[16:17], v[24:25]
    v_pk_fma_f32 v[154:155], v[154:155], v[18:19], v[26:27]
    v_pk_fma_f32 v[156:157], v[156:157], v[20:21], v[28:29]
    v_pk_fma_f32 v[158:159], v[158:159], v[22:23], v[30:31]
    v_pk_fma_f32 v[160:161], v[160:161], v[16:17], v[24:25]
    v_pk_fma_f32 v[162:163], v[162:163], v[18:19], v[26:27]
    v_pk_fma_f32 v[164:165], v[164:165], v[20:21], v[28:29]
    v_pk_fma_f32 v[166:167], v[166:167], v[22:23], v[30:31]
    v_pk_fma_f32 v[168:169], v[168:169], v[16:17], v[24:25]
    v_pk_fma_f32 v[170:171], v[170:171], v[18:19], v[26:27]
    v_pk_fma_f32 v[172:173], v[172:173], v[20:21], v[28:29]
    v_pk_fma_f32 v[174:175], v[174:175], v[22:23], v[30:31]
    v_dot2_f32_bf16 v244, v208, s9, 0
    v_dot2_f32_bf16 v248, v208, v208, 0
    v_dot2_f32_bf16 v245, v212, s9, 0
    v_dot2_f32_bf16 v249, v212, v212, 0
    v_dot2_f32_bf16 v246, v216, s9, 0
    v_dot2_f32_bf16 v250, v216, v216, 0
    v_dot2_f32_bf16 v247, v220, s9, 0
    v_dot2_f32_bf16 v251, v220, v220, 0
    v_dot2_f32_bf16 v244, v209, s9, v244
    v_dot2_f32_bf16 v248, v209, v209, v248
    v_dot2_f32_bf16 v245, v213, s9, v245
    v_dot2_f32_bf16 v249, v213, v213, v249
    v_dot2_f32_bf16 v246, v217, s9, v246
    v_dot2_f32_bf16 v250, v217, v217, v250
    v_dot2_f32_bf16 v247, v221, s9, v247
    v_dot2_f32_bf16 v251, v221, v221, v251
    v_dot2_f32_bf16 v244, v210, s9, v244
    v_dot2_f32_bf16 v248, v210, v210, v248
    v_dot2_f32_bf16 v245, v214, s9, v245
    v_dot2_f32_bf16 v249, v214, v214, v249
    v_dot2_f32_bf16 v246, v218, s9, v246
    v_dot2_f32_bf16 v250, v218, v218, v250
    v_dot2_f32_bf16 v247, v222, s9, v247
    v_dot2_f32_bf16 v251, v222, v222, v251
    v_dot2_f32_bf16 v244, v211, s9, v244
    v_dot2_f32_bf16 v248, v211, v211, v248
    v_dot2_f32_bf16 v245, v215, s9, v245
    v_dot2_f32_bf16 v249, v215, v215, v249
    v_dot2_f32_bf16 v246, v219, s9, v246
    v_dot2_f32_bf16 v250, v219, v219, v250
    v_dot2_f32_bf16 v247, v223, s9, v247
    v_dot2_f32_bf16 v251, v223, v223, v251
    v_add_f32_dpp v244, v244, v244 row_ror:8 row_mask:0xf bank_mask:0x3
    v_add_f32_dpp v248, v248, v248 row_ror:8 row_mask:0xf bank_mask:0x3
    v_add_f32_dpp v246, v246, v246 row_ror:8 row_mask:0xf bank_mask:0x3
    v_add_f32_dpp v250, v250, v250 row_ror:8 row_mask:0xf bank_mask:0x3
    v_add_f32_dpp v244, v245, v245 row_ror:8 row_mask:0xf bank_mask:0xc
    v_add_f32_dpp v248, v249, v249 row_ror:8 row_mask:0xf bank_mask:0xc
    v_add_f32_dpp v246, v247, v247 row_ror:8 row_mask:0xf bank_mask:0xc
    v_add_f32_dpp v250, v251, v251 row_ror:8 row_mask:0xf bank_mask:0xc
    v_add_f32_dpp v244, v244, v244 row_half_mirror row_mask:0xf bank_mask:0x5
    v_add_f32_dpp v248, v248, v248 row_half_mirror row_mask:0xf bank_mask:0x5
    s_nop 0
    v_add_f32_dpp v244, v246, v246 row_half_mirror row_mask:0xf bank_mask:0xa
    v_add_f32_dpp v248, v250, v250 row_half_mirror row_mask:0xf bank_mask:0xa
    s_nop 1
    v_permlane32_swap_b32 v244, v248
    v_add_f32 v244, v244, v248
    s_nop 1
    v_add_f32_dpp v244, v244, v244 quad_perm:[1,0,3,2] row_mask:0xf bank_mask:0xf
    s_nop 1
    v_add_f32_dpp v244, v244, v244 quad_perm:[2,3,0,1] row_mask:0xf bank_mask:0xf
    v_mov_b32 v245, v244
    s_nop 1
    v_permlane16_swap_b32 v245, v244
    v_add_f32 v244, v244, v245
    v_mul_f32 v244, s10, v244
    v_mov_b32 v245, v244
    s_nop 1
    v_permlane32_swap_b32 v245, v244
    v_fma_f32 v244, -v245, v245, v244
    v_max_f32 v244, 0, v244
    v_add_f32 v244, s11, v244
    v_rsq_f32 v244, v244
    s_nop 0
    v_mul_f32_e64 v245, -v245, v244
    v_readlane_b32 s48, v244, 0
    v_readlane_b32 s50, v244, 8
    v_readlane_b32 s52, v244, 4
    v_readlane_b32 s54, v244, 12
    v_readlane_b32 s49, v245, 0
    v_readlane_b32 s51, v245, 8
    v_readlane_b32 s53, v245, 4
    v_readlane_b32 s55, v245, 12
    s_xor_b64 s[72:73], s[20:21], s[76:77]
    s_xor_b64 s[74:75], s[22:23], s[76:77]
    s_or_b64 s[72:73], s[72:73], s[74:75]
    s_cmp_eq_u64 s[72:73], 0
    s_cbranch_scc0 L_retry_44
L_ok_43:
    s_add_u32 m0, s5, 32768
    s_add_u32 s67, s4, 0
    v_xor_b32_e64 v241, 0, v240
    buffer_load_dwordx4 v241, s[24:27], s67 offen sc1 lds
    s_add_u32 m0, s5, 33792
    s_add_u32 s67, s4, 66560
    v_xor_b32_e64 v241, 16, v240
    buffer_load_dwordx4 v241, s[24:27], s67 offen sc1 lds
    s_add_u32 m0, s5, 34816
    s_add_u32 s67, s4, 133120
    v_xor_b32_e64 v241, 32, v240
    buffer_load_dwordx4 v241, s[24:27], s67 offen sc1 lds
    s_add_u32 m0, s5, 35840
    s_add_u32 s67, s4, 199680
    v_xor_b32_e64 v241, 48, v240
    buffer_load_dwordx4 v241, s[24:27], s67 offen sc1 lds
    s_add_u32 m0, s5, 36864
    s_add_u32 s67, s78, 266240
    v_xor_b32_e64 v241, 64, v240
    buffer_load_dwordx4 v241, s[24:27], s67 offen sc1 lds
    s_add_u32 m0, s5, 37888
    s_add_u32 s67, s78, 332800
    v_xor_b32 v241, 80, v240
    buffer_load_dwordx4 v241, s[24:27], s67 offen sc1 lds
    s_add_u32 m0, s5, 38912
    s_add_u32 s67, s78, 399360
    v_xor_b32 v241, 96, v240
    buffer_load_dwordx4 v241, s[24:27], s67 offen sc1 lds
    s_add_u32 m0, s5, 39936
    s_add_u32 s67, s78, 465920
    v_xor_b32 v241, 112, v240
    buffer_load_dwordx4 v241, s[24:27], s67 offen sc1 lds
    s_waitcnt vmcnt(0)
    s_barrier
    ds_read_b64 v[192:193], v242 offset:32768
    ds_read_b64 v[196:197], v242 offset:33024
    ds_read_b64 v[200:201], v242 offset:33280
    ds_read_b64 v[204:205], v242 offset:33536
    ds_read_b64 v[194:195], v243 offset:32768
    ds_read_b64 v[198:199], v243 offset:33024
    ds_read_b64 v[202:203], v243 offset:33280
    ds_read_b64 v[206:207], v243 offset:33536
    s_waitcnt lgkmcnt(7)
    v_lshlrev_b32 v6, 16, v192
    v_and_b32 v7, s71, v192
    s_waitcnt lgkmcnt(6)
    v_lshlrev_b32 v8, 16, v196
    v_and_b32 v9, s71, v196
    s_waitcnt lgkmcnt(5)
    v_lshlrev_b32 v10, 16, v200
    v_and_b32 v11, s71, v200
    s_waitcnt lgkmcnt(4)
    v_lshlrev_b32 v12, 16, v204
    v_and_b32 v13, s71, v204
    v_pk_fma_f32 v[48:49], v[80:81], v[6:7], v[48:49]
    v_pk_fma_f32 v[50:51], v[82:83], v[8:9], v[50:51]
    v_pk_fma_f32 v[52:53], v[84:85], v[10:11], v[52:53]
    v_pk_fma_f32 v[54:55], v[86:87], v[12:13], v[54:55]
    v_cvt_pk_bf16_f32 v208, v48, v49
    v_cvt_pk_bf16_f32 v209, v50, v51
    v_cvt_pk_bf16_f32 v210, v52, v53
    v_cvt_pk_bf16_f32 v211, v54, v55
    v_lshlrev_b32 v6, 16, v193
    v_and_b32 v7, s71, v193
    v_lshlrev_b32 v8, 16, v197
    v_and_b32 v9, s71, v197
    v_lshlrev_b32 v10, 16, v201
    v_and_b32 v11, s71, v201
    v_lshlrev_b32 v12, 16, v205
    v_and_b32 v13, s71, v205
    v_pk_fma_f32 v[56:57], v[88:89], v[6:7], v[56:57]
    v_pk_fma_f32 v[58:59], v[90:91], v[8:9], v[58:59]
    v_pk_fma_f32 v[60:61], v[92:93], v[10:11], v[60:61]
    v_pk_fma_f32 v[62:63], v[94:95], v[12:13], v[62:63]
    v_cvt_pk_bf16_f32 v212, v56, v57
    v_cvt_pk_bf16_f32 v213, v58, v59
    v_cvt_pk_bf16_f32 v214, v60, v61
    v_cvt_pk_bf16_f32 v215, v62, v63
    s_waitcnt lgkmcnt(3)
    v_lshlrev_b32 v6, 16, v194
    v_and_b32 v7, s71, v194
    s_waitcnt lgkmcnt(2)
    v_lshlrev_b32 v8, 16, v198
    v_and_b32 v9, s71, v198
    s_waitcnt lgkmcnt(1)
    v_lshlrev_b32 v10, 16, v202
    v_and_b32 v11, s71, v202
    s_waitcnt lgkmcnt(0)
    v_lshlrev_b32 v12, 16, v206
    v_and_b32 v13, s71, v206
    v_pk_fma_f32 v[64:65], v[96:97], v[6:7], v[64:65]
    v_pk_fma_f32 v[66:67], v[98:99], v[8:9], v[66:67]
    v_pk_fma_f32 v[68:69], v[100:101], v[10:11], v[68:69]
    v_pk_fma_f32 v[70:71], v[102:103], v[12:13], v[70:71]
    v_cvt_pk_bf16_f32 v216, v64, v65
    v_cvt_pk_bf16_f32 v217, v66, v67
    v_cvt_pk_bf16_f32 v218, v68, v69
    v_cvt_pk_bf16_f32 v219, v70, v71
    v_lshlrev_b32 v6, 16, v195
    v_and_b32 v7, s71, v195
    v_lshlrev_b32 v8, 16, v199
    v_and_b32 v9, s71, v199
    v_lshlrev_b32 v10, 16, v203
    v_and_b32 v11, s71, v203
    v_lshlrev_b32 v12, 16, v207
    v_and_b32 v13, s71, v207
    v_pk_fma_f32 v[72:73], v[104:105], v[6:7], v[72:73]
    v_pk_fma_f32 v[74:75], v[106:107], v[8:9], v[74:75]
    v_pk_fma_f32 v[76:77], v[108:109], v[10:11], v[76:77]
    v_pk_fma_f32 v[78:79], v[110:111], v[12:13], v[78:79]
    v_cvt_pk_bf16_f32 v220, v72, v73
    v_cvt_pk_bf16_f32 v221, v74, v75
    v_cvt_pk_bf16_f32 v222, v76, v77
    v_cvt_pk_bf16_f32 v223, v78, v79
    v_dot2_f32_bf16 v244, v208, s9, 0
    v_dot2_f32_bf16 v248, v208, v208, 0
    v_dot2_f32_bf16 v245, v212, s9, 0
    v_dot2_f32_bf16 v249, v212, v212, 0
    v_dot2_f32_bf16 v246, v216, s9, 0
    v_dot2_f32_bf16 v250, v216, v216, 0
    v_dot2_f32_bf16 v247, v220, s9, 0
    v_dot2_f32_bf16 v251, v220, v220, 0
    v_dot2_f32_bf16 v244, v209, s9, v244
    v_dot2_f32_bf16 v248, v209, v209, v248
    v_dot2_f32_bf16 v245, v213, s9, v245
    v_dot2_f32_bf16 v249, v213, v213, v249
    v_dot2_f32_bf16 v246, v217, s9, v246
    v_dot2_f32_bf16 v250, v217, v217, v250
    v_dot2_f32_bf16 v247, v221, s9, v247
    v_dot2_f32_bf16 v251, v221, v221, v251
    v_dot2_f32_bf16 v244, v210, s9, v244
    v_dot2_f32_bf16 v248, v210, v210, v248
    v_dot2_f32_bf16 v245, v214, s9, v245
    v_dot2_f32_bf16 v249, v214, v214, v249
    v_dot2_f32_bf16 v246, v218, s9, v246
    v_dot2_f32_bf16 v250, v218, v218, v250
    v_dot2_f32_bf16 v247, v222, s9, v247
    v_dot2_f32_bf16 v251, v222, v222, v251
    v_dot2_f32_bf16 v244, v211, s9, v244
    v_dot2_f32_bf16 v248, v211, v211, v248
    v_dot2_f32_bf16 v245, v215, s9, v245
    v_dot2_f32_bf16 v249, v215, v215, v249
    v_dot2_f32_bf16 v246, v219, s9, v246
    v_dot2_f32_bf16 v250, v219, v219, v250
    v_dot2_f32_bf16 v247, v223, s9, v247
    v_dot2_f32_bf16 v251, v223, v223, v251
    v_add_f32_dpp v244, v244, v244 row_ror:8 row_mask:0xf bank_mask:0x3
    v_add_f32_dpp v248, v248, v248 row_ror:8 row_mask:0xf bank_mask:0x3
    v_add_f32_dpp v246, v246, v246 row_ror:8 row_mask:0xf bank_mask:0x3
    v_add_f32_dpp v250, v250, v250 row_ror:8 row_mask:0xf bank_mask:0x3
    v_add_f32_dpp v244, v245, v245 row_ror:8 row_mask:0xf bank_mask:0xc
    v_add_f32_dpp v248, v249, v249 row_ror:8 row_mask:0xf bank_mask:0xc
    v_add_f32_dpp v246, v247, v247 row_ror:8 row_mask:0xf bank_mask:0xc
    v_add_f32_dpp v250, v251, v251 row_ror:8 row_mask:0xf bank_mask:0xc
    v_add_f32_dpp v244, v244, v244 row_half_mirror row_mask:0xf bank_mask:0x5
    v_add_f32_dpp v248, v248, v248 row_half_mirror row_mask:0xf bank_mask:0x5
    s_nop 0
    v_add_f32_dpp v244, v246, v246 row_half_mirror row_mask:0xf bank_mask:0xa
    v_add_f32_dpp v248, v250, v250 row_half_mirror row_mask:0xf bank_mask:0xa
    s_nop 1
    v_permlane32_swap_b32 v244, v248
    v_add_f32 v244, v244, v248
    s_nop 1
    v_add_f32_dpp v244, v244, v244 quad_perm:[1,0,3,2] row_mask:0xf bank_mask:0xf
    s_nop 1
    v_add_f32_dpp v244, v244, v244 quad_perm:[2,3,0,1] row_mask:0xf bank_mask:0xf
    v_mov_b32 v245, v244
    s_nop 1
    v_permlane16_swap_b32 v245, v244
    v_add_f32 v244, v244, v245
    v_mul_f32 v244, s10, v244
    v_mov_b32 v245, v244
    s_nop 1
    v_permlane32_swap_b32 v245, v244
    v_fma_f32 v244, -v245, v245, v244
    v_max_f32 v244, 0, v244
    v_add_f32 v244, s11, v244
    v_rsq_f32 v244, v244
    s_nop 0
    v_mul_f32_e64 v245, -v245, v244
    v_readlane_b32 s28, v244, 0
    v_readlane_b32 s30, v244, 8
    v_readlane_b32 s32, v244, 4
    v_readlane_b32 s34, v244, 12
    v_readlane_b32 s29, v245, 0
    v_readlane_b32 s31, v245, 8
    v_readlane_b32 s33, v245, 4
    v_readlane_b32 s35, v245, 12
    s_mov_b32 s69, 2883584
    v_pk_fma_f32 v[48:49], v[48:49], s[28:29], s[28:29] op_sel:[0,0,1] op_sel_hi:[1,0,1]
    v_pk_fma_f32 v[50:51], v[50:51], s[28:29], s[28:29] op_sel:[0,0,1] op_sel_hi:[1,0,1]
    v_pk_fma_f32 v[52:53], v[52:53], s[28:29], s[28:29] op_sel:[0,0,1] op_sel_hi:[1,0,1]
    v_pk_fma_f32 v[54:55], v[54:55], s[28:29], s[28:29] op_sel:[0,0,1] op_sel_hi:[1,0,1]
    v_pk_fma_f32 v[48:49], v[48:49], v[32:33], v[40:41]
    v_pk_fma_f32 v[50:51], v[50:51], v[34:35], v[42:43]
    v_pk_fma_f32 v[52:53], v[52:53], v[36:37], v[44:45]
    v_pk_fma_f32 v[54:55], v[54:55], v[38:39], v[46:47]
    v_cvt_pk_bf16_f32 v176, v48, v49
    v_cvt_pk_bf16_f32 v177, v50, v51
    v_cvt_pk_bf16_f32 v178, v52, v53
    v_cvt_pk_bf16_f32 v179, v54, v55
    buffer_store_dwordx4 v[176:179], v3, s[24:27], s69 offen offset:0 sc0 sc1
    v_pk_fma_f32 v[56:57], v[56:57], s[30:31], s[30:31] op_sel:[0,0,1] op_sel_hi:[1,0,1]
    v_pk_fma_f32 v[58:59], v[58:59], s[30:31], s[30:31] op_sel:[0,0,1] op_sel_hi:[1,0,1]
    v_pk_fma_f32 v[60:61], v[60:61], s[30:31], s[30:31] op_sel:[0,0,1] op_sel_hi:[1,0,1]
    v_pk_fma_f32 v[62:63], v[62:63], s[30:31], s[30:31] op_sel:[0,0,1] op_sel_hi:[1,0,1]
    v_pk_fma_f32 v[56:57], v[56:57], v[32:33], v[40:41]
    v_pk_fma_f32 v[58:59], v[58:59], v[34:35], v[42:43]
    v_pk_fma_f32 v[60:61], v[60:61], v[36:37], v[44:45]
    v_pk_fma_f32 v[62:63], v[62:63], v[38:39], v[46:47]
    v_cvt_pk_bf16_f32 v180, v56, v57
    v_cvt_pk_bf16_f32 v181, v58, v59
    v_cvt_pk_bf16_f32 v182, v60, v61
    v_cvt_pk_bf16_f32 v183, v62, v63
    buffer_store_dwordx4 v[180:183], v3, s[24:27], s69 offen offset:896 sc0 sc1
    v_pk_fma_f32 v[64:65], v[64:65], s[32:33], s[32:33] op_sel:[0,0,1] op_sel_hi:[1,0,1]
    v_pk_fma_f32 v[66:67], v[66:67], s[32:33], s[32:33] op_sel:[0,0,1] op_sel_hi:[1,0,1]
    v_pk_fma_f32 v[68:69], v[68:69], s[32:33], s[32:33] op_sel:[0,0,1] op_sel_hi:[1,0,1]
    v_pk_fma_f32 v[70:71], v[70:71], s[32:33], s[32:33] op_sel:[0,0,1] op_sel_hi:[1,0,1]
    v_pk_fma_f32 v[64:65], v[64:65], v[32:33], v[40:41]
    v_pk_fma_f32 v[66:67], v[66:67], v[34:35], v[42:43]
    v_pk_fma_f32 v[68:69], v[68:69], v[36:37], v[44:45]
    v_pk_fma_f32 v[70:71], v[70:71], v[38:39], v[46:47]
    v_cvt_pk_bf16_f32 v184, v64, v65
    v_cvt_pk_bf16_f32 v185, v66, v67
    v_cvt_pk_bf16_f32 v186, v68, v69
    v_cvt_pk_bf16_f32 v187, v70, v71
    buffer_store_dwordx4 v[184:187], v3, s[24:27], s69 offen offset:1792 sc0 sc1
    v_pk_fma_f32 v[72:73], v[72:73], s[34:35], s[34:35] op_sel:[0,0,1] op_sel_hi:[1,0,1]
    v_pk_fma_f32 v[74:75], v[74:75], s[34:35], s[34:35] op_sel:[0,0,1] op_sel_hi:[1,0,1]
    v_pk_fma_f32 v[76:77], v[76:77], s[34:35], s[34:35] op_sel:[0,0,1] op_sel_hi:[1,0,1]
    v_pk_fma_f32 v[78:79], v[78:79], s[34:35], s[34:35] op_sel:[0,0,1] op_sel_hi:[1,0,1]
    v_pk_fma_f32 v[72:73], v[72:73], v[32:33], v[40:41]
    v_pk_fma_f32 v[74:75], v[74:75], v[34:35], v[42:43]
    v_pk_fma_f32 v[76:77], v[76:77], v[36:37], v[44:45]
    v_pk_fma_f32 v[78:79], v[78:79], v[38:39], v[46:47]
    v_cvt_pk_bf16_f32 v188, v72, v73
    v_cvt_pk_bf16_f32 v189, v74, v75
    v_cvt_pk_bf16_f32 v190, v76, v77
    v_cvt_pk_bf16_f32 v191, v78, v79
    buffer_store_dwordx4 v[188:191], v3, s[24:27], s69 offen offset:2688 sc0 sc1
    ds_read_b64 v[192:193], v242 offset:32776
    ds_read_b64 v[196:197], v242 offset:33032
    ds_read_b64 v[200:201], v242 offset:33288
    ds_read_b64 v[204:205], v242 offset:33544
    ds_read_b64 v[194:195], v243 offset:32776
    ds_read_b64 v[198:199], v243 offset:33032
    ds_read_b64 v[202:203], v243 offset:33288
    ds_read_b64 v[206:207], v243 offset:33544
    s_waitcnt lgkmcnt(0)
    s_add_u32 s7, s12, 16384
    s_mov_b32 s20, 0
    s_atomic_add s20, s[24:25], s7 glc
    s_add_u32 s7, s13, 16384
    s_mov_b32 s21, 0
    s_atomic_add s21, s[24:25], s7 glc
    s_add_u32 s7, s14, 16384
    s_mov_b32 s22, 0
    s_atomic_add s22, s[24:25], s7 glc
    s_add_u32 s7, s15, 16384
    s_mov_b32 s23, 0
    s_atomic_add s23, s[24:25], s7 glc
    v_lshlrev_b32 v6, 16, v192
    v_and_b32 v7, s71, v192
    v_lshlrev_b32 v8, 16, v196
    v_and_b32 v9, s71, v196
    v_lshlrev_b32 v10, 16, v200
    v_and_b32 v11, s71, v200
    v_lshlrev_b32 v12, 16, v204
    v_and_b32_e64 v13, s71, v204
    v_pk_fma_f32 v[112:113], v[144:145], v[6:7], v[112:113]
    v_pk_fma_f32 v[114:115], v[146:147], v[8:9], v[114:115]
    v_pk_fma_f32 v[116:117], v[148:149], v[10:11], v[116:117]
    v_pk_fma_f32 v[118:119], v[150:151], v[12:13], v[118:119]
    v_cvt_pk_bf16_f32 v224, v112, v113
    v_cvt_pk_bf16_f32 v225, v114, v115
    v_cvt_pk_bf16_f32 v226, v116, v117
    v_cvt_pk_bf16_f32 v227, v118, v119
    v_lshlrev_b32 v6, 16, v193
    v_and_b32 v7, s71, v193
    v_lshlrev_b32 v8, 16, v197
    v_and_b32 v9, s71, v197
    v_lshlrev_b32 v10, 16, v201
    v_and_b32 v11, s71, v201
    v_lshlrev_b32 v12, 16, v205
    v_and_b32 v13, s71, v205
    v_pk_fma_f32 v[120:121], v[152:153], v[6:7], v[120:121]
    v_pk_fma_f32 v[122:123], v[154:155], v[8:9], v[122:123]
    v_pk_fma_f32 v[124:125], v[156:157], v[10:11], v[124:125]
    v_pk_fma_f32 v[126:127], v[158:159], v[12:13], v[126:127]
    v_cvt_pk_bf16_f32 v228, v120, v121
    v_cvt_pk_bf16_f32 v229, v122, v123
    v_cvt_pk_bf16_f32 v230, v124, v125
    v_cvt_pk_bf16_f32 v231, v126, v127
    v_lshlrev_b32 v6, 16, v194
    v_and_b32 v7, s71, v194
    v_lshlrev_b32 v8, 16, v198
    v_and_b32 v9, s71, v198
    v_lshlrev_b32 v10, 16, v202
    v_and_b32 v11, s71, v202
    v_lshlrev_b32 v12, 16, v206
    v_and_b32 v13, s71, v206
    v_pk_fma_f32 v[128:129], v[160:161], v[6:7], v[128:129]
    v_pk_fma_f32 v[130:131], v[162:163], v[8:9], v[130:131]
    v_pk_fma_f32 v[132:133], v[164:165], v[10:11], v[132:133]
    v_pk_fma_f32 v[134:135], v[166:167], v[12:13], v[134:135]
    v_cvt_pk_bf16_f32 v232, v128, v129
    v_cvt_pk_bf16_f32 v233, v130, v131
    v_cvt_pk_bf16_f32 v234, v132, v133
    v_cvt_pk_bf16_f32 v235, v134, v135
    v_lshlrev_b32 v6, 16, v195
    v_and_b32 v7, s71, v195
    v_lshlrev_b32 v8, 16, v199
    v_and_b32 v9, s71, v199
    v_lshlrev_b32 v10, 16, v203
    v_and_b32 v11, s71, v203
    v_lshlrev_b32 v12, 16, v207
    v_and_b32 v13, s71, v207
    v_pk_fma_f32 v[136:137], v[168:169], v[6:7], v[136:137]
    v_pk_fma_f32 v[138:139], v[170:171], v[8:9], v[138:139]
    v_pk_fma_f32 v[140:141], v[172:173], v[10:11], v[140:141]
    v_pk_fma_f32 v[142:143], v[174:175], v[12:13], v[142:143]
    v_cvt_pk_bf16_f32 v236, v136, v137
    v_cvt_pk_bf16_f32 v237, v138, v139
    v_cvt_pk_bf16_f32 v238, v140, v141
    v_cvt_pk_bf16_f32 v239, v142, v143
    v_dot2_f32_bf16 v244, v224, s9, 0
    v_dot2_f32_bf16 v248, v224, v224, 0
    v_dot2_f32_bf16 v245, v228, s9, 0
    v_dot2_f32_bf16 v249, v228, v228, 0
    v_dot2_f32_bf16 v246, v232, s9, 0
    v_dot2_f32_bf16 v250, v232, v232, 0
    v_dot2_f32_bf16 v247, v236, s9, 0
    v_dot2_f32_bf16 v251, v236, v236, 0
    v_dot2_f32_bf16 v244, v225, s9, v244
    v_dot2_f32_bf16 v248, v225, v225, v248
    v_dot2_f32_bf16 v245, v229, s9, v245
    v_dot2_f32_bf16 v249, v229, v229, v249
    v_dot2_f32_bf16 v246, v233, s9, v246
    v_dot2_f32_bf16 v250, v233, v233, v250
    v_dot2_f32_bf16 v247, v237, s9, v247
    v_dot2_f32_bf16 v251, v237, v237, v251
    v_dot2_f32_bf16 v244, v226, s9, v244
    v_dot2_f32_bf16 v248, v226, v226, v248
    v_dot2_f32_bf16 v245, v230, s9, v245
    v_dot2_f32_bf16 v249, v230, v230, v249
    v_dot2_f32_bf16 v246, v234, s9, v246
    s_add_u32 s66, s8, 0
    s_waitcnt vmcnt(0)
    s_atomic_add s3, s[24:25], s66
    v_dot2_f32_bf16 v250, v234, v234, v250
    v_dot2_f32_bf16 v247, v238, s9, v247
    v_dot2_f32_bf16 v251, v238, v238, v251
    v_dot2_f32_bf16 v244, v227, s9, v244
    v_dot2_f32_bf16 v248, v227, v227, v248
    v_dot2_f32_bf16 v245, v231, s9, v245
    v_dot2_f32_bf16 v249, v231, v231, v249
    v_dot2_f32_bf16 v246, v235, s9, v246
    v_dot2_f32_bf16 v250, v235, v235, v250
    v_dot2_f32_bf16 v247, v239, s9, v247
    v_dot2_f32_bf16 v251, v239, v239, v251
    v_add_f32_dpp v244, v244, v244 row_ror:8 row_mask:0xf bank_mask:0x3
    v_add_f32_dpp v248, v248, v248 row_ror:8 row_mask:0xf bank_mask:0x3
    v_add_f32_dpp v246, v246, v246 row_ror:8 row_mask:0xf bank_mask:0x3
    v_add_f32_dpp v250, v250, v250 row_ror:8 row_mask:0xf bank_mask:0x3
    v_add_f32_dpp v244, v245, v245 row_ror:8 row_mask:0xf bank_mask:0xc
    v_add_f32_dpp v248, v249, v249 row_ror:8 row_mask:0xf bank_mask:0xc
    v_add_f32_dpp v246, v247, v247 row_ror:8 row_mask:0xf bank_mask:0xc
    v_add_f32_dpp v250, v251, v251 row_ror:8 row_mask:0xf bank_mask:0xc
    v_add_f32_dpp v244, v244, v244 row_half_mirror row_mask:0xf bank_mask:0x5
    v_add_f32_dpp v248, v248, v248 row_half_mirror row_mask:0xf bank_mask:0x5
    s_nop 0
    v_add_f32_dpp v244, v246, v246 row_half_mirror row_mask:0xf bank_mask:0xa
    v_add_f32_dpp v248, v250, v250 row_half_mirror row_mask:0xf bank_mask:0xa
    s_nop 1
    v_permlane32_swap_b32 v244, v248
    v_add_f32 v244, v244, v248
    s_nop 1
    v_add_f32_dpp v244, v244, v244 quad_perm:[1,0,3,2] row_mask:0xf bank_mask:0xf
    s_nop 1
    v_add_f32_dpp v244, v244, v244 quad_perm:[2,3,0,1] row_mask:0xf bank_mask:0xf
    v_mov_b32 v245, v244
    s_nop 1
    v_permlane16_swap_b32 v245, v244
    v_add_f32 v244, v244, v245
    v_mul_f32 v244, s10, v244
    v_mov_b32 v245, v244
    s_nop 1
    v_permlane32_swap_b32 v245, v244
    v_fma_f32 v244, -v245, v245, v244
    v_max_f32 v244, 0, v244
    v_add_f32 v244, s11, v244
    v_rsq_f32 v244, v244
    s_nop 0
    v_mul_f32_e64 v245, -v245, v244
    v_readlane_b32 s28, v244, 0
    v_readlane_b32 s30, v244, 8
    v_readlane_b32 s32, v244, 4
    v_readlane_b32 s34, v244, 12
    v_readlane_b32 s29, v245, 0
    v_readlane_b32 s31, v245, 8
    v_readlane_b32 s33, v245, 4
    v_readlane_b32 s35, v245, 12
    s_mov_b32 s69, 3342336
    v_pk_fma_f32 v[112:113], v[112:113], s[28:29], s[28:29] op_sel:[0,0,1] op_sel_hi:[1,0,1]
    v_pk_fma_f32 v[114:115], v[114:115], s[28:29], s[28:29] op_sel:[0,0,1] op_sel_hi:[1,0,1]
    v_pk_fma_f32 v[116:117], v[116:117], s[28:29], s[28:29] op_sel:[0,0,1] op_sel_hi:[1,0,1]
    v_pk_fma_f32 v[118:119], v[118:119], s[28:29], s[28:29] op_sel:[0,0,1] op_sel_hi:[1,0,1]
    v_pk_fma_f32 v[112:113], v[112:113], v[32:33], v[40:41]
    v_pk_fma_f32 v[114:115], v[114:115], v[34:35], v[42:43]
    v_pk_fma_f32 v[116:117], v[116:117], v[36:37], v[44:45]
    v_pk_fma_f32 v[118:119], v[118:119], v[38:39], v[46:47]
    v_cvt_pk_bf16_f32 v176, v112, v113
    v_cvt_pk_bf16_f32 v177, v114, v115
    v_cvt_pk_bf16_f32 v178, v116, v117
    v_cvt_pk_bf16_f32 v179, v118, v119
    buffer_store_dwordx4 v[176:179], v3, s[24:27], s69 offen offset:0 sc0 sc1
    v_pk_fma_f32 v[120:121], v[120:121], s[30:31], s[30:31] op_sel:[0,0,1] op_sel_hi:[1,0,1]
    v_pk_fma_f32 v[122:123], v[122:123], s[30:31], s[30:31] op_sel:[0,0,1] op_sel_hi:[1,0,1]
    v_pk_fma_f32 v[124:125], v[124:125], s[30:31], s[30:31] op_sel:[0,0,1] op_sel_hi:[1,0,1]
    v_pk_fma_f32 v[126:127], v[126:127], s[30:31], s[30:31] op_sel:[0,0,1] op_sel_hi:[1,0,1]
    v_pk_fma_f32 v[120:121], v[120:121], v[32:33], v[40:41]
    v_pk_fma_f32 v[122:123], v[122:123], v[34:35], v[42:43]
    v_pk_fma_f32 v[124:125], v[124:125], v[36:37], v[44:45]
    v_pk_fma_f32 v[126:127], v[126:127], v[38:39], v[46:47]
    v_cvt_pk_bf16_f32 v180, v120, v121
    v_cvt_pk_bf16_f32 v181, v122, v123
    v_cvt_pk_bf16_f32 v182, v124, v125
    v_cvt_pk_bf16_f32 v183, v126, v127
    buffer_store_dwordx4 v[180:183], v3, s[24:27], s69 offen offset:896 sc0 sc1
    v_pk_fma_f32 v[128:129], v[128:129], s[32:33], s[32:33] op_sel:[0,0,1] op_sel_hi:[1,0,1]
    v_pk_fma_f32 v[130:131], v[130:131], s[32:33], s[32:33] op_sel:[0,0,1] op_sel_hi:[1,0,1]
    v_pk_fma_f32 v[132:133], v[132:133], s[32:33], s[32:33] op_sel:[0,0,1] op_sel_hi:[1,0,1]
    v_pk_fma_f32 v[134:135], v[134:135], s[32:33], s[32:33] op_sel:[0,0,1] op_sel_hi:[1,0,1]
    v_pk_fma_f32 v[128:129], v[128:129], v[32:33], v[40:41]
    v_pk_fma_f32 v[130:131], v[130:131], v[34:35], v[42:43]
    v_pk_fma_f32 v[132:133], v[132:133], v[36:37], v[44:45]
    v_pk_fma_f32 v[134:135], v[134:135], v[38:39], v[46:47]
    v_cvt_pk_bf16_f32 v184, v128, v129
    v_cvt_pk_bf16_f32 v185, v130, v131
    v_cvt_pk_bf16_f32 v186, v132, v133
    v_cvt_pk_bf16_f32 v187, v134, v135
    buffer_store_dwordx4 v[184:187], v3, s[24:27], s69 offen offset:1792 sc0 sc1
    v_pk_fma_f32 v[136:137], v[136:137], s[34:35], s[34:35] op_sel:[0,0,1] op_sel_hi:[1,0,1]
    v_pk_fma_f32 v[138:139], v[138:139], s[34:35], s[34:35] op_sel:[0,0,1] op_sel_hi:[1,0,1]
    v_pk_fma_f32 v[140:141], v[140:141], s[34:35], s[34:35] op_sel:[0,0,1] op_sel_hi:[1,0,1]
    v_pk_fma_f32 v[142:143], v[142:143], s[34:35], s[34:35] op_sel:[0,0,1] op_sel_hi:[1,0,1]
    v_pk_fma_f32 v[136:137], v[136:137], v[32:33], v[40:41]
    v_pk_fma_f32 v[138:139], v[138:139], v[34:35], v[42:43]
    v_pk_fma_f32 v[140:141], v[140:141], v[36:37], v[44:45]
    v_pk_fma_f32 v[142:143], v[142:143], v[38:39], v[46:47]
    v_cvt_pk_bf16_f32 v188, v136, v137
    v_cvt_pk_bf16_f32 v189, v138, v139
    v_cvt_pk_bf16_f32 v190, v140, v141
    v_cvt_pk_bf16_f32 v191, v142, v143
    buffer_store_dwordx4 v[188:191], v3, s[24:27], s69 offen offset:2688 sc0 sc1
    s_xor_b64 s[72:73], s[20:21], s[76:77]
    s_xor_b64 s[74:75], s[22:23], s[76:77]
    s_or_b64 s[72:73], s[72:73], s[74:75]
    s_cmp_eq_u64 s[72:73], 0
    s_cbranch_scc0 L_retry_47
L_ok_46:
    ds_read_b128 v[80:83], v252 offset:8192
    ds_read_b128 v[84:87], v252 offset:9216
    ds_read_b128 v[88:91], v252 offset:10240
    ds_read_b128 v[92:95], v252 offset:11264
    s_add_u32 m0, s5, 0
    s_add_u32 s67, s4, 4096
    v_xor_b32_e64 v241, 0, v240
    buffer_load_dwordx4 v241, s[24:27], s67 offen sc1 lds
    ds_read_b32 v15, v14
    s_waitcnt lgkmcnt(1)
    v_lshlrev_b32 v48, 16, v80
    v_and_b32 v49, s71, v80
    v_lshlrev_b32 v50, 16, v81
    v_and_b32 v51, s71, v81
    v_lshlrev_b32 v52, 16, v82
    v_and_b32 v53, s71, v82
    v_lshlrev_b32 v54, 16, v83
    s_add_u32 m0, s5, 1024
    s_add_u32 s67, s4, 70656
    v_xor_b32_e64 v241, 16, v240
    buffer_load_dwordx4 v241, s[24:27], s67 offen sc1 lds
    v_and_b32 v55, s71, v83
    v_lshlrev_b32 v56, 16, v84
    v_and_b32 v57, s71, v84
    v_lshlrev_b32 v58, 16, v85
    v_and_b32 v59, s71, v85
    v_lshlrev_b32 v60, 16, v86
    v_and_b32 v61, s71, v86
    v_lshlrev_b32 v62, 16, v87
    s_add_u32 m0, s5, 2048
    s_add_u32 s67, s4, 137216
    v_xor_b32_e64 v241, 32, v240
    buffer_load_dwordx4 v241, s[24:27], s67 offen sc1 lds
    v_and_b32 v63, s71, v87
    v_lshlrev_b32 v64, 16, v88
    v_and_b32 v65, s71, v88
    v_lshlrev_b32 v66, 16, v89
    v_and_b32 v67, s71, v89
    v_lshlrev_b32 v68, 16, v90
    v_and_b32 v69, s71, v90
    v_lshlrev_b32 v70, 16, v91
    s_add_u32 m0, s5, 3072
    s_add_u32 s67, s4, 203776
    v_xor_b32_e64 v241, 48, v240
    buffer_load_dwordx4 v241, s[24:27], s67 offen sc1 lds
    v_and_b32 v71, s71, v91
    v_lshlrev_b32 v72, 16, v92
    v_and_b32 v73, s71, v92
    v_lshlrev_b32 v74, 16, v93
    v_and_b32 v75, s71, v93
    v_lshlrev_b32 v76, 16, v94
    v_and_b32 v77, s71, v94
    v_lshlrev_b32 v78, 16, v95
    s_add_u32 m0, s5, 4096
    s_add_u32 s67, s78, 270336
    v_xor_b32_e64 v241, 64, v240
    buffer_load_dwordx4 v241, s[24:27], s67 offen sc1 lds
    v_and_b32_e64 v79, s71, v95
    v_pk_fma_f32 v[80:81], v[48:49], s[40:41], s[40:41] op_sel:[0,0,1] op_sel_hi:[1,0,1]
    v_pk_fma_f32 v[82:83], v[50:51], s[40:41], s[40:41] op_sel:[0,0,1] op_sel_hi:[1,0,1]
    v_pk_fma_f32 v[84:85], v[52:53], s[40:41], s[40:41] op_sel:[0,0,1] op_sel_hi:[1,0,1]
    v_pk_fma_f32 v[86:87], v[54:55], s[40:41], s[40:41] op_sel:[0,0,1] op_sel_hi:[1,0,1]
    v_pk_fma_f32 v[88:89], v[56:57], s[42:43], s[42:43] op_sel:[0,0,1] op_sel_hi:[1,0,1]
    v_pk_fma_f32 v[90:91], v[58:59], s[42:43], s[42:43] op_sel:[0,0,1] op_sel_hi:[1,0,1]
    v_pk_fma_f32 v[92:93], v[60:61], s[42:43], s[42:43] op_sel:[0,0,1] op_sel_hi:[1,0,1]
    s_add_u32 m0, s5, 5120
    s_add_u32 s67, s78, 336896
    v_xor_b32 v241, 80, v240
    buffer_load_dwordx4 v241, s[24:27], s67 offen sc1 lds
    v_pk_fma_f32 v[94:95], v[62:63], s[42:43], s[42:43] op_sel:[0,0,1] op_sel_hi:[1,0,1]
    v_pk_fma_f32 v[96:97], v[64:65], s[44:45], s[44:45] op_sel:[0,0,1] op_sel_hi:[1,0,1]
    v_pk_fma_f32 v[98:99], v[66:67], s[44:45], s[44:45] op_sel:[0,0,1] op_sel_hi:[1,0,1]
    v_pk_fma_f32 v[100:101], v[68:69], s[44:45], s[44:45] op_sel:[0,0,1] op_sel_hi:[1,0,1]
    v_pk_fma_f32 v[102:103], v[70:71], s[44:45], s[44:45] op_sel:[0,0,1] op_sel_hi:[1,0,1]
    v_pk_fma_f32 v[104:105], v[72:73], s[46:47], s[46:47] op_sel:[0,0,1] op_sel_hi:[1,0,1]
    v_pk_fma_f32 v[106:107], v[74:75], s[46:47], s[46:47] op_sel:[0,0,1] op_sel_hi:[1,0,1]
    v_pk_fma_f32 v[108:109], v[76:77], s[46:47], s[46:47] op_sel:[0,0,1] op_sel_hi:[1,0,1]
    s_add_u32 m0, s5, 6144
    s_add_u32 s67, s78, 403456
    v_xor_b32 v241, 96, v240
    buffer_load_dwordx4 v241, s[24:27], s67 offen sc1 lds
    v_pk_fma_f32 v[110:111], v[78:79], s[46:47], s[46:47] op_sel:[0,0,1] op_sel_hi:[1,0,1]
    v_pk_fma_f32 v[80:81], v[80:81], v[16:17], v[24:25]
    v_pk_fma_f32 v[82:83], v[82:83], v[18:19], v[26:27]
    v_pk_fma_f32 v[84:85], v[84:85], v[20:21], v[28:29]
    v_pk_fma_f32 v[86:87], v[86:87], v[22:23], v[30:31]
    v_pk_fma_f32 v[88:89], v[88:89], v[16:17], v[24:25]
    v_pk_fma_f32 v[90:91], v[90:91], v[18:19], v[26:27]
    v_pk_fma_f32 v[92:93], v[92:93], v[20:21], v[28:29]
    s_add_u32 m0, s5, 7168
    s_add_u32 s67, s78, 470016
    v_xor_b32 v241, 112, v240
    buffer_load_dwordx4 v241, s[24:27], s67 offen sc1 lds
    v_pk_fma_f32 v[94:95], v[94:95], v[22:23], v[30:31]
    v_pk_fma_f32 v[96:97], v[96:97], v[16:17], v[24:25]
    v_pk_fma_f32 v[98:99], v[98:99], v[18:19], v[26:27]
    v_pk_fma_f32 v[100:101], v[100:101], v[20:21], v[28:29]
    v_pk_fma_f32 v[102:103], v[102:103], v[22:23], v[30:31]
    v_pk_fma_f32 v[104:105], v[104:105], v[16:17], v[24:25]
    v_pk_fma_f32 v[106:107], v[106:107], v[18:19], v[26:27]
    v_pk_fma_f32 v[108:109], v[108:109], v[20:21], v[28:29]
    v_pk_fma_f32 v[110:111], v[110:111], v[22:23], v[30:31]
    s_add_u32 s66, s8, 16384
    s_waitcnt vmcnt(8)
    s_atomic_add s3, s[24:25], s66
    s_waitcnt vmcnt(0)
    s_nop 0
    s_barrier
    ds_read_b64 v[192:193], v242 offset:0
    ds_read_b64 v[196:197], v242 offset:256
    ds_read_b64 v[200:201], v242 offset:512
    ds_read_b64 v[204:205], v242 offset:768
    ds_read_b64 v[194:195], v243 offset:0
    ds_read_b64 v[198:199], v243 offset:256
    ds_read_b64 v[202:203], v243 offset:512
    ds_read_b64 v[206:207], v243 offset:768
    s_waitcnt lgkmcnt(7)
    v_lshlrev_b32 v6, 16, v192
    v_and_b32 v7, s71, v192
    s_waitcnt lgkmcnt(6)
    v_lshlrev_b32 v8, 16, v196
    v_and_b32 v9, s71, v196
    s_waitcnt lgkmcnt(5)
    v_lshlrev_b32 v10, 16, v200
    v_and_b32 v11, s71, v200
    s_waitcnt lgkmcnt(4)
    v_lshlrev_b32 v12, 16, v204
    v_and_b32 v13, s71, v204
    v_pk_fma_f32 v[48:49], v[80:81], v[6:7], v[48:49]
    v_pk_fma_f32 v[50:51], v[82:83], v[8:9], v[50:51]
    v_pk_fma_f32 v[52:53], v[84:85], v[10:11], v[52:53]
    v_pk_fma_f32 v[54:55], v[86:87], v[12:13], v[54:55]
    v_cvt_pk_bf16_f32 v80, v48, v49
    v_cvt_pk_bf16_f32 v81, v50, v51
    v_cvt_pk_bf16_f32 v82, v52, v53
    v_cvt_pk_bf16_f32 v83, v54, v55
    v_lshlrev_b32 v6, 16, v193
    v_and_b32 v7, s71, v193
    v_lshlrev_b32 v8, 16, v197
    v_and_b32 v9, s71, v197
    v_lshlrev_b32 v10, 16, v201
    v_and_b32 v11, s71, v201
    v_lshlrev_b32 v12, 16, v205
    v_and_b32 v13, s71, v205
    v_pk_fma_f32 v[56:57], v[88:89], v[6:7], v[56:57]
    v_pk_fma_f32 v[58:59], v[90:91], v[8:9], v[58:59]
    v_pk_fma_f32 v[60:61], v[92:93], v[10:11], v[60:61]
    v_pk_fma_f32 v[62:63], v[94:95], v[12:13], v[62:63]
    v_cvt_pk_bf16_f32 v88, v56, v57
    v_cvt_pk_bf16_f32 v89, v58, v59
    v_cvt_pk_bf16_f32 v90, v60, v61
    v_cvt_pk_bf16_f32 v91, v62, v63
    s_waitcnt lgkmcnt(3)
    v_lshlrev_b32 v6, 16, v194
    v_and_b32 v7, s71, v194
    s_waitcnt lgkmcnt(2)
    v_lshlrev_b32 v8, 16, v198
    v_and_b32 v9, s71, v198
    s_waitcnt lgkmcnt(1)
    v_lshlrev_b32 v10, 16, v202
    v_and_b32_e64 v11, s71, v202
    ds_read_b32 v15, v14
    s_waitcnt lgkmcnt(1)
    v_lshlrev_b32 v12, 16, v206
    v_and_b32_e64 v13, s71, v206
    v_pk_fma_f32 v[64:65], v[96:97], v[6:7], v[64:65]
    v_pk_fma_f32 v[66:67], v[98:99], v[8:9], v[66:67]
    v_pk_fma_f32 v[68:69], v[100:101], v[10:11], v[68:69]
    v_pk_fma_f32 v[70:71], v[102:103], v[12:13], v[70:71]
    v_cvt_pk_bf16_f32 v96, v64, v65
    v_cvt_pk_bf16_f32 v97, v66, v67
    v_cvt_pk_bf16_f32 v98, v68, v69
    v_cvt_pk_bf16_f32 v99, v70, v71
    v_lshlrev_b32 v6, 16, v195
    v_and_b32 v7, s71, v195
    v_lshlrev_b32 v8, 16, v199
    v_and_b32 v9, s71, v199
    v_lshlrev_b32 v10, 16, v203
    v_and_b32 v11, s71, v203
    v_lshlrev_b32 v12, 16, v207
    v_and_b32 v13, s71, v207
    v_pk_fma_f32 v[72:73], v[104:105], v[6:7], v[72:73]
    v_pk_fma_f32 v[74:75], v[106:107], v[8:9], v[74:75]
    v_pk_fma_f32 v[76:77], v[108:109], v[10:11], v[76:77]
    v_pk_fma_f32 v[78:79], v[110:111], v[12:13], v[78:79]
    v_cvt_pk_bf16_f32 v104, v72, v73
    v_cvt_pk_bf16_f32 v105, v74, v75
    v_cvt_pk_bf16_f32 v106, v76, v77
    v_cvt_pk_bf16_f32 v107, v78, v79
    v_dot2_f32_bf16 v244, v80, s9, 0
    v_dot2_f32_bf16 v248, v80, v80, 0
    v_dot2_f32_bf16 v245, v88, s9, 0
    v_dot2_f32_bf16 v249, v88, v88, 0
    v_dot2_f32_bf16 v246, v96, s9, 0
    v_dot2_f32_bf16 v250, v96, v96, 0
    v_dot2_f32_bf16 v247, v104, s9, 0
    v_dot2_f32_bf16 v251, v104, v104, 0
    v_dot2_f32_bf16 v244, v81, s9, v244
    v_dot2_f32_bf16 v248, v81, v81, v248
    v_dot2_f32_bf16 v245, v89, s9, v245
    v_dot2_f32_bf16 v249, v89, v89, v249
    v_dot2_f32_bf16 v246, v97, s9, v246
    v_dot2_f32_bf16 v250, v97, v97, v250
    v_dot2_f32_bf16 v247, v105, s9, v247
    v_dot2_f32_bf16 v251, v105, v105, v251
    v_dot2_f32_bf16 v244, v82, s9, v244
    v_dot2_f32_bf16 v248, v82, v82, v248
    v_dot2_f32_bf16 v245, v90, s9, v245
    v_dot2_f32_bf16 v249, v90, v90, v249
    v_dot2_f32_bf16 v246, v98, s9, v246
    v_dot2_f32_bf16 v250, v98, v98, v250
    v_dot2_f32_bf16 v247, v106, s9, v247
    v_dot2_f32_bf16 v251, v106, v106, v251
    v_dot2_f32_bf16 v244, v83, s9, v244
    v_dot2_f32_bf16 v248, v83, v83, v248
    v_dot2_f32_bf16 v245, v91, s9, v245
    v_dot2_f32_bf16 v249, v91, v91, v249
    v_dot2_f32_bf16 v246, v99, s9, v246
    v_dot2_f32_bf16 v250, v99, v99, v250
    v_dot2_f32_bf16 v247, v107, s9, v247
    v_dot2_f32_bf16 v251, v107, v107, v251
    v_add_f32_dpp v244, v244, v244 row_ror:8 row_mask:0xf bank_mask:0x3
    v_add_f32_dpp v248, v248, v248 row_ror:8 row_mask:0xf bank_mask:0x3
    v_add_f32_dpp v246, v246, v246 row_ror:8 row_mask:0xf bank_mask:0x3
    v_add_f32_dpp v250, v250, v250 row_ror:8 row_mask:0xf bank_mask:0x3
    v_add_f32_dpp v244, v245, v245 row_ror:8 row_mask:0xf bank_mask:0xc
    v_add_f32_dpp v248, v249, v249 row_ror:8 row_mask:0xf bank_mask:0xc
    v_add_f32_dpp v246, v247, v247 row_ror:8 row_mask:0xf bank_mask:0xc
    v_add_f32_dpp v250, v251, v251 row_ror:8 row_mask:0xf bank_mask:0xc
    v_add_f32_dpp v244, v244, v244 row_half_mirror row_mask:0xf bank_mask:0x5
    v_add_f32_dpp v248, v248, v248 row_half_mirror row_mask:0xf bank_mask:0x5
    s_nop 0
    v_add_f32_dpp v244, v246, v246 row_half_mirror row_mask:0xf bank_mask:0xa
    v_add_f32_dpp v248, v250, v250 row_half_mirror row_mask:0xf bank_mask:0xa
    s_nop 1
    v_permlane32_swap_b32 v244, v248
    v_add_f32 v244, v244, v248
    s_nop 1
    v_add_f32_dpp v244, v244, v244 quad_perm:[1,0,3,2] row_mask:0xf bank_mask:0xf
    s_nop 1
    v_add_f32_dpp v244, v244, v244 quad_perm:[2,3,0,1] row_mask:0xf bank_mask:0xf
    v_mov_b32 v245, v244
    s_nop 1
    v_permlane16_swap_b32 v245, v244
    v_add_f32 v244, v244, v245
    v_mul_f32 v244, s10, v244
    v_mov_b32 v245, v244
    s_nop 1
    v_permlane32_swap_b32 v245, v244
    v_fma_f32 v244, -v245, v245, v244
    v_max_f32 v244, 0, v244
    v_add_f32 v244, s11, v244
    v_rsq_f32 v244, v244
    s_nop 0
    v_mul_f32_e64 v245, -v245, v244
    v_readlane_b32 s28, v244, 0
    v_readlane_b32 s30, v244, 8
    v_readlane_b32 s32, v244, 4
    v_readlane_b32 s34, v244, 12
    v_readlane_b32 s29, v245, 0
    v_readlane_b32 s31, v245, 8
    v_readlane_b32 s33, v245, 4
    v_readlane_b32 s35, v245, 12
    s_mov_b32 s69, 3801088
    v_pk_fma_f32 v[48:49], v[48:49], s[28:29], s[28:29] op_sel:[0,0,1] op_sel_hi:[1,0,1]
    v_pk_fma_f32 v[50:51], v[50:51], s[28:29], s[28:29] op_sel:[0,0,1] op_sel_hi:[1,0,1]
    v_pk_fma_f32 v[52:53], v[52:53], s[28:29], s[28:29] op_sel:[0,0,1] op_sel_hi:[1,0,1]
    v_pk_fma_f32 v[54:55], v[54:55], s[28:29], s[28:29] op_sel:[0,0,1] op_sel_hi:[1,0,1]
    v_pk_fma_f32 v[48:49], v[48:49], v[32:33], v[40:41]
    v_pk_fma_f32 v[50:51], v[50:51], v[34:35], v[42:43]
    v_pk_fma_f32 v[52:53], v[52:53], v[36:37], v[44:45]
    v_pk_fma_f32 v[54:55], v[54:55], v[38:39], v[46:47]
    v_cvt_pk_bf16_f32 v176, v48, v49
    v_cvt_pk_bf16_f32 v177, v50, v51
    v_cvt_pk_bf16_f32 v178, v52, v53
    v_cvt_pk_bf16_f32 v179, v54, v55
    buffer_store_dwordx4 v[176:179], v3, s[24:27], s69 offen offset:0 sc0 sc1
    v_pk_fma_f32 v[56:57], v[56:57], s[30:31], s[30:31] op_sel:[0,0,1] op_sel_hi:[1,0,1]
    v_pk_fma_f32 v[58:59], v[58:59], s[30:31], s[30:31] op_sel:[0,0,1] op_sel_hi:[1,0,1]
    v_pk_fma_f32 v[60:61], v[60:61], s[30:31], s[30:31] op_sel:[0,0,1] op_sel_hi:[1,0,1]
    v_pk_fma_f32 v[62:63], v[62:63], s[30:31], s[30:31] op_sel:[0,0,1] op_sel_hi:[1,0,1]
    v_pk_fma_f32 v[56:57], v[56:57], v[32:33], v[40:41]
    v_pk_fma_f32 v[58:59], v[58:59], v[34:35], v[42:43]
    v_pk_fma_f32 v[60:61], v[60:61], v[36:37], v[44:45]
    v_pk_fma_f32 v[62:63], v[62:63], v[38:39], v[46:47]
    v_cvt_pk_bf16_f32 v180, v56, v57
    v_cvt_pk_bf16_f32 v181, v58, v59
    v_cvt_pk_bf16_f32 v182, v60, v61
    v_cvt_pk_bf16_f32 v183, v62, v63
    buffer_store_dwordx4 v[180:183], v3, s[24:27], s69 offen offset:896 sc0 sc1
    v_pk_fma_f32 v[64:65], v[64:65], s[32:33], s[32:33] op_sel:[0,0,1] op_sel_hi:[1,0,1]
    v_pk_fma_f32 v[66:67], v[66:67], s[32:33], s[32:33] op_sel:[0,0,1] op_sel_hi:[1,0,1]
    v_pk_fma_f32 v[68:69], v[68:69], s[32:33], s[32:33] op_sel:[0,0,1] op_sel_hi:[1,0,1]
    v_pk_fma_f32 v[70:71], v[70:71], s[32:33], s[32:33] op_sel:[0,0,1] op_sel_hi:[1,0,1]
    v_pk_fma_f32 v[64:65], v[64:65], v[32:33], v[40:41]
    v_pk_fma_f32 v[66:67], v[66:67], v[34:35], v[42:43]
    v_pk_fma_f32 v[68:69], v[68:69], v[36:37], v[44:45]
    v_pk_fma_f32 v[70:71], v[70:71], v[38:39], v[46:47]
    v_cvt_pk_bf16_f32 v184, v64, v65
    v_cvt_pk_bf16_f32 v185, v66, v67
    v_cvt_pk_bf16_f32 v186, v68, v69
    v_cvt_pk_bf16_f32 v187, v70, v71
    buffer_store_dwordx4 v[184:187], v3, s[24:27], s69 offen offset:1792 sc0 sc1
    v_pk_fma_f32 v[72:73], v[72:73], s[34:35], s[34:35] op_sel:[0,0,1] op_sel_hi:[1,0,1]
    v_pk_fma_f32 v[74:75], v[74:75], s[34:35], s[34:35] op_sel:[0,0,1] op_sel_hi:[1,0,1]
    v_pk_fma_f32 v[76:77], v[76:77], s[34:35], s[34:35] op_sel:[0,0,1] op_sel_hi:[1,0,1]
    v_pk_fma_f32 v[78:79], v[78:79], s[34:35], s[34:35] op_sel:[0,0,1] op_sel_hi:[1,0,1]
    v_pk_fma_f32 v[72:73], v[72:73], v[32:33], v[40:41]
    v_pk_fma_f32 v[74:75], v[74:75], v[34:35], v[42:43]
    v_pk_fma_f32 v[76:77], v[76:77], v[36:37], v[44:45]
    v_pk_fma_f32 v[78:79], v[78:79], v[38:39], v[46:47]
    v_cvt_pk_bf16_f32 v188, v72, v73
    v_cvt_pk_bf16_f32 v189, v74, v75
    v_cvt_pk_bf16_f32 v190, v76, v77
    v_cvt_pk_bf16_f32 v191, v78, v79
    buffer_store_dwordx4 v[188:191], v3, s[24:27], s69 offen offset:2688 sc0 sc1
    ds_read_b128 v[144:147], v252 offset:12288
    ds_read_b128 v[148:151], v252 offset:13312
    ds_read_b128 v[152:155], v252 offset:14336
    ds_read_b128 v[156:159], v252 offset:15360
    s_waitcnt lgkmcnt(0)
    v_lshlrev_b32 v112, 16, v144
    v_and_b32 v113, s71, v144
    v_lshlrev_b32 v114, 16, v145
    v_and_b32 v115, s71, v145
    v_lshlrev_b32 v116, 16, v146
    v_and_b32 v117, s71, v146
    v_lshlrev_b32 v118, 16, v147
    v_and_b32 v119, s71, v147
    v_lshlrev_b32 v120, 16, v148
    v_and_b32 v121, s71, v148
    v_lshlrev_b32 v122, 16, v149
    v_and_b32 v123, s71, v149
    v_lshlrev_b32 v124, 16, v150
    v_and_b32 v125, s71, v150
    v_lshlrev_b32 v126, 16, v151
    v_and_b32 v127, s71, v151
    v_lshlrev_b32 v128, 16, v152
    v_and_b32 v129, s71, v152
    v_lshlrev_b32 v130, 16, v153
    v_and_b32 v131, s71, v153
    v_lshlrev_b32 v132, 16, v154
    v_and_b32 v133, s71, v154
    v_lshlrev_b32 v134, 16, v155
    v_and_b32 v135, s71, v155
    v_lshlrev_b32 v136, 16, v156
    v_and_b32 v137, s71, v156
    v_lshlrev_b32 v138, 16, v157
    v_and_b32 v139, s71, v157
    v_lshlrev_b32 v140, 16, v158
    v_and_b32 v141, s71, v158
    v_lshlrev_b32 v142, 16, v159
    v_and_b32_e64 v143, s71, v159
    v_pk_fma_f32 v[144:145], v[112:113], s[48:49], s[48:49] op_sel:[0,0,1] op_sel_hi:[1,0,1]
    v_pk_fma_f32 v[146:147], v[114:115], s[48:49], s[48:49] op_sel:[0,0,1] op_sel_hi:[1,0,1]
    v_pk_fma_f32 v[148:149], v[116:117], s[48:49], s[48:49] op_sel:[0,0,1] op_sel_hi:[1,0,1]
    v_pk_fma_f32 v[150:151], v[118:119], s[48:49], s[48:49] op_sel:[0,0,1] op_sel_hi:[1,0,1]
    v_pk_fma_f32 v[152:153], v[120:121], s[50:51], s[50:51] op_sel:[0,0,1] op_sel_hi:[1,0,1]
    v_pk_fma_f32 v[154:155], v[122:123], s[50:51], s[50:51] op_sel:[0,0,1] op_sel_hi:[1,0,1]
    v_pk_fma_f32 v[156:157], v[124:125], s[50:51], s[50:51] op_sel:[0,0,1] op_sel_hi:[1,0,1]
    v_pk_fma_f32 v[158:159], v[126:127], s[50:51], s[50:51] op_sel:[0,0,1] op_sel_hi:[1,0,1]
    v_pk_fma_f32 v[160:161], v[128:129], s[52:53], s[52:53] op_sel:[0,0,1] op_sel_hi:[1,0,1]
    v_pk_fma_f32 v[162:163], v[130:131], s[52:53], s[52:53] op_sel:[0,0,1] op_sel_hi:[1,0,1]
    v_pk_fma_f32 v[164:165], v[132:133], s[52:53], s[52:53] op_sel:[0,0,1] op_sel_hi:[1,0,1]
    v_pk_fma_f32 v[166:167], v[134:135], s[52:53], s[52:53] op_sel:[0,0,1] op_sel_hi:[1,0,1]
    v_pk_fma_f32 v[168:169], v[136:137], s[54:55], s[54:55] op_sel:[0,0,1] op_sel_hi:[1,0,1]
    v_pk_fma_f32 v[170:171], v[138:139], s[54:55], s[54:55] op_sel:[0,0,1] op_sel_hi:[1,0,1]
    v_pk_fma_f32 v[172:173], v[140:141], s[54:55], s[54:55] op_sel:[0,0,1] op_sel_hi:[1,0,1]
    v_pk_fma_f32 v[174:175], v[142:143], s[54:55], s[54:55] op_sel:[0,0,1] op_sel_hi:[1,0,1]
    v_pk_fma_f32 v[144:145], v[144:145], v[16:17], v[24:25]
    v_pk_fma_f32 v[146:147], v[146:147], v[18:19], v[26:27]
    v_pk_fma_f32 v[148:149], v[148:149], v[20:21], v[28:29]
    v_pk_fma_f32 v[150:151], v[150:151], v[22:23], v[30:31]
    v_pk_fma_f32 v[152:153], v[152:153], v[16:17], v[24:25]
    v_pk_fma_f32 v[154:155], v[154:155], v[18:19], v[26:27]
    v_pk_fma_f32 v[156:157], v[156:157], v[20:21], v[28:29]
    v_pk_fma_f32 v[158:159], v[158:159], v[22:23], v[30:31]
    v_pk_fma_f32 v[160:161], v[160:161], v[16:17], v[24:25]
    v_pk_fma_f32 v[162:163], v[162:163], v[18:19], v[26:27]
    v_pk_fma_f32 v[164:165], v[164:165], v[20:21], v[28:29]
    v_pk_fma_f32 v[166:167], v[166:167], v[22:23], v[30:31]
    v_pk_fma_f32 v[168:169], v[168:169], v[16:17], v[24:25]
    v_pk_fma_f32 v[170:171], v[170:171], v[18:19], v[26:27]
    v_pk_fma_f32 v[172:173], v[172:173], v[20:21], v[28:29]
    v_pk_fma_f32 v[174:175], v[174:175], v[22:23], v[30:31]
    ds_read_b64 v[192:193], v242 offset:8
    ds_read_b64 v[196:197], v242 offset:264
    ds_read_b64 v[200:201], v242 offset:520
    ds_read_b64 v[204:205], v242 offset:776
    ds_read_b64 v[194:195], v243 offset:8
    ds_read_b64 v[198:199], v243 offset:264
    ds_read_b64 v[202:203], v243 offset:520
    ds_read_b64 v[206:207], v243 offset:776
    s_waitcnt lgkmcnt(7)
    v_lshlrev_b32 v6, 16, v192
    v_and_b32 v7, s71, v192
    s_waitcnt lgkmcnt(6)
    v_lshlrev_b32 v8, 16, v196
    v_and_b32 v9, s71, v196
    s_waitcnt lgkmcnt(5)
    v_lshlrev_b32 v10, 16, v200
    v_and_b32 v11, s71, v200
    s_waitcnt lgkmcnt(4)
    v_lshlrev_b32 v12, 16, v204
    v_and_b32 v13, s71, v204
    v_pk_fma_f32 v[112:113], v[144:145], v[6:7], v[112:113]
    v_pk_fma_f32 v[114:115], v[146:147], v[8:9], v[114:115]
    v_pk_fma_f32 v[116:117], v[148:149], v[10:11], v[116:117]
    v_pk_fma_f32 v[118:119], v[150:151], v[12:13], v[118:119]
    v_cvt_pk_bf16_f32 v144, v112, v113
    v_cvt_pk_bf16_f32 v145, v114, v115
    v_cvt_pk_bf16_f32 v146, v116, v117
    v_cvt_pk_bf16_f32 v147, v118, v119
    s_add_u32 s66, s8, 32768
    s_waitcnt vmcnt(0)
    s_atomic_add s3, s[24:25], s66
    v_lshlrev_b32 v6, 16, v193
    v_and_b32 v7, s71, v193
    v_lshlrev_b32 v8, 16, v197
    v_and_b32 v9, s71, v197
    v_lshlrev_b32 v10, 16, v201
    v_and_b32 v11, s71, v201
    v_lshlrev_b32 v12, 16, v205
    v_and_b32_e64 v13, s71, v205
    v_pk_fma_f32 v[120:121], v[152:153], v[6:7], v[120:121]
    v_pk_fma_f32 v[122:123], v[154:155], v[8:9], v[122:123]
    v_pk_fma_f32 v[124:125], v[156:157], v[10:11], v[124:125]
    v_pk_fma_f32 v[126:127], v[158:159], v[12:13], v[126:127]
    v_cvt_pk_bf16_f32 v152, v120, v121
    v_cvt_pk_bf16_f32 v153, v122, v123
    v_cvt_pk_bf16_f32 v154, v124, v125
    v_cvt_pk_bf16_f32 v155, v126, v127
    s_waitcnt lgkmcnt(3)
    v_lshlrev_b32 v6, 16, v194
    v_and_b32 v7, s71, v194
    s_waitcnt lgkmcnt(2)
    v_lshlrev_b32 v8, 16, v198
    v_and_b32 v9, s71, v198
    s_waitcnt lgkmcnt(1)
    v_lshlrev_b32 v10, 16, v202
    v_and_b32_e64 v11, s71, v202
    ds_read_b32 v15, v14
    s_waitcnt lgkmcnt(1)
    v_lshlrev_b32 v12, 16, v206
    v_and_b32_e64 v13, s71, v206
    v_pk_fma_f32 v[128:129], v[160:161], v[6:7], v[128:129]
    v_pk_fma_f32 v[130:131], v[162:163], v[8:9], v[130:131]
    v_pk_fma_f32 v[132:133], v[164:165], v[10:11], v[132:133]
    v_pk_fma_f32 v[134:135], v[166:167], v[12:13], v[134:135]
    v_cvt_pk_bf16_f32 v160, v128, v129
    v_cvt_pk_bf16_f32 v161, v130, v131
    v_cvt_pk_bf16_f32 v162, v132, v133
    v_cvt_pk_bf16_f32 v163, v134, v135
    v_lshlrev_b32 v6, 16, v195
    v_and_b32 v7, s71, v195
    v_lshlrev_b32 v8, 16, v199
    v_and_b32 v9, s71, v199
    v_lshlrev_b32 v10, 16, v203
    v_and_b32 v11, s71, v203
    v_lshlrev_b32 v12, 16, v207
    v_and_b32 v13, s71, v207
    v_pk_fma_f32 v[136:137], v[168:169], v[6:7], v[136:137]
    v_pk_fma_f32 v[138:139], v[170:171], v[8:9], v[138:139]
    v_pk_fma_f32 v[140:141], v[172:173], v[10:11], v[140:141]
    v_pk_fma_f32 v[142:143], v[174:175], v[12:13], v[142:143]
    v_cvt_pk_bf16_f32 v168, v136, v137
    v_cvt_pk_bf16_f32 v169, v138, v139
    v_cvt_pk_bf16_f32 v170, v140, v141
    v_cvt_pk_bf16_f32 v171, v142, v143
    v_dot2_f32_bf16 v244, v144, s9, 0
    v_dot2_f32_bf16 v248, v144, v144, 0
    v_dot2_f32_bf16 v245, v152, s9, 0
    v_dot2_f32_bf16 v249, v152, v152, 0
    v_dot2_f32_bf16 v246, v160, s9, 0
    v_dot2_f32_bf16 v250, v160, v160, 0
    v_dot2_f32_bf16 v247, v168, s9, 0
    v_dot2_f32_bf16 v251, v168, v168, 0
    v_dot2_f32_bf16 v244, v145, s9, v244
    v_dot2_f32_bf16 v248, v145, v145, v248
    v_dot2_f32_bf16 v245, v153, s9, v245
    v_dot2_f32_bf16 v249, v153, v153, v249
    v_dot2_f32_bf16 v246, v161, s9, v246
    v_dot2_f32_bf16 v250, v161, v161, v250
    v_dot2_f32_bf16 v247, v169, s9, v247
    v_dot2_f32_bf16 v251, v169, v169, v251
    v_dot2_f32_bf16 v244, v146, s9, v244
    v_dot2_f32_bf16 v248, v146, v146, v248
    v_dot2_f32_bf16 v245, v154, s9, v245
    v_dot2_f32_bf16 v249, v154, v154, v249
    v_dot2_f32_bf16 v246, v162, s9, v246
    v_dot2_f32_bf16 v250, v162, v162, v250
    v_dot2_f32_bf16 v247, v170, s9, v247
    v_dot2_f32_bf16 v251, v170, v170, v251
    v_dot2_f32_bf16 v244, v147, s9, v244
    v_dot2_f32_bf16 v248, v147, v147, v248
    v_dot2_f32_bf16 v245, v155, s9, v245
    v_dot2_f32_bf16 v249, v155, v155, v249
    v_dot2_f32_bf16 v246, v163, s9, v246
    v_dot2_f32_bf16 v250, v163, v163, v250
    v_dot2_f32_bf16 v247, v171, s9, v247
    v_dot2_f32_bf16 v251, v171, v171, v251
    v_add_f32_dpp v244, v244, v244 row_ror:8 row_mask:0xf bank_mask:0x3
    v_add_f32_dpp v248, v248, v248 row_ror:8 row_mask:0xf bank_mask:0x3
    v_add_f32_dpp v246, v246, v246 row_ror:8 row_mask:0xf bank_mask:0x3
    v_add_f32_dpp v250, v250, v250 row_ror:8 row_mask:0xf bank_mask:0x3
    v_add_f32_dpp v244, v245, v245 row_ror:8 row_mask:0xf bank_mask:0xc
    v_add_f32_dpp v248, v249, v249 row_ror:8 row_mask:0xf bank_mask:0xc
    v_add_f32_dpp v246, v247, v247 row_ror:8 row_mask:0xf bank_mask:0xc
    v_add_f32_dpp v250, v251, v251 row_ror:8 row_mask:0xf bank_mask:0xc
    v_add_f32_dpp v244, v244, v244 row_half_mirror row_mask:0xf bank_mask:0x5
    v_add_f32_dpp v248, v248, v248 row_half_mirror row_mask:0xf bank_mask:0x5
    s_nop 0
    v_add_f32_dpp v244, v246, v246 row_half_mirror row_mask:0xf bank_mask:0xa
    v_add_f32_dpp v248, v250, v250 row_half_mirror row_mask:0xf bank_mask:0xa
    s_nop 1
    v_permlane32_swap_b32 v244, v248
    v_add_f32 v244, v244, v248
    s_nop 1
    v_add_f32_dpp v244, v244, v244 quad_perm:[1,0,3,2] row_mask:0xf bank_mask:0xf
    s_nop 1
    v_add_f32_dpp v244, v244, v244 quad_perm:[2,3,0,1] row_mask:0xf bank_mask:0xf
    v_mov_b32 v245, v244
    s_nop 1
    v_permlane16_swap_b32 v245, v244
    v_add_f32 v244, v244, v245
    v_mul_f32 v244, s10, v244
    v_mov_b32 v245, v244
    s_nop 1
    v_permlane32_swap_b32 v245, v244
    v_fma_f32 v244, -v245, v245, v244
    v_max_f32 v244, 0, v244
    v_add_f32 v244, s11, v244
    v_rsq_f32 v244, v244
    s_nop 0
    v_mul_f32_e64 v245, -v245, v244
    v_readlane_b32 s28, v244, 0
    v_readlane_b32 s30, v244, 8
    v_readlane_b32 s32, v244, 4
    v_readlane_b32 s34, v244, 12
    v_readlane_b32 s29, v245, 0
    v_readlane_b32 s31, v245, 8
    v_readlane_b32 s33, v245, 4
    v_readlane_b32 s35, v245, 12
    s_mov_b32 s69, 4259840
    v_pk_fma_f32 v[112:113], v[112:113], s[28:29], s[28:29] op_sel:[0,0,1] op_sel_hi:[1,0,1]
    v_pk_fma_f32 v[114:115], v[114:115], s[28:29], s[28:29] op_sel:[0,0,1] op_sel_hi:[1,0,1]
    v_pk_fma_f32 v[116:117], v[116:117], s[28:29], s[28:29] op_sel:[0,0,1] op_sel_hi:[1,0,1]
    v_pk_fma_f32 v[118:119], v[118:119], s[28:29], s[28:29] op_sel:[0,0,1] op_sel_hi:[1,0,1]
    v_pk_fma_f32 v[112:113], v[112:113], v[32:33], v[40:41]
    v_pk_fma_f32 v[114:115], v[114:115], v[34:35], v[42:43]
    v_pk_fma_f32 v[116:117], v[116:117], v[36:37], v[44:45]
    v_pk_fma_f32 v[118:119], v[118:119], v[38:39], v[46:47]
    v_cvt_pk_bf16_f32 v176, v112, v113
    v_cvt_pk_bf16_f32 v177, v114, v115
    v_cvt_pk_bf16_f32 v178, v116, v117
    v_cvt_pk_bf16_f32 v179, v118, v119
    buffer_store_dwordx4 v[176:179], v3, s[24:27], s69 offen offset:0 sc0 sc1
    v_pk_fma_f32 v[120:121], v[120:121], s[30:31], s[30:31] op_sel:[0,0,1] op_sel_hi:[1,0,1]
    v_pk_fma_f32 v[122:123], v[122:123], s[30:31], s[30:31] op_sel:[0,0,1] op_sel_hi:[1,0,1]
    v_pk_fma_f32 v[124:125], v[124:125], s[30:31], s[30:31] op_sel:[0,0,1] op_sel_hi:[1,0,1]
    v_pk_fma_f32 v[126:127], v[126:127], s[30:31], s[30:31] op_sel:[0,0,1] op_sel_hi:[1,0,1]
    v_pk_fma_f32 v[120:121], v[120:121], v[32:33], v[40:41]
    v_pk_fma_f32 v[122:123], v[122:123], v[34:35], v[42:43]
    v_pk_fma_f32 v[124:125], v[124:125], v[36:37], v[44:45]
    v_pk_fma_f32 v[126:127], v[126:127], v[38:39], v[46:47]
    v_cvt_pk_bf16_f32 v180, v120, v121
    v_cvt_pk_bf16_f32 v181, v122, v123
    v_cvt_pk_bf16_f32 v182, v124, v125
    v_cvt_pk_bf16_f32 v183, v126, v127
    buffer_store_dwordx4 v[180:183], v3, s[24:27], s69 offen offset:896 sc0 sc1
    v_pk_fma_f32 v[128:129], v[128:129], s[32:33], s[32:33] op_sel:[0,0,1] op_sel_hi:[1,0,1]
    v_pk_fma_f32 v[130:131], v[130:131], s[32:33], s[32:33] op_sel:[0,0,1] op_sel_hi:[1,0,1]
    v_pk_fma_f32 v[132:133], v[132:133], s[32:33], s[32:33] op_sel:[0,0,1] op_sel_hi:[1,0,1]
    v_pk_fma_f32 v[134:135], v[134:135], s[32:33], s[32:33] op_sel:[0,0,1] op_sel_hi:[1,0,1]
    v_pk_fma_f32 v[128:129], v[128:129], v[32:33], v[40:41]
    v_pk_fma_f32 v[130:131], v[130:131], v[34:35], v[42:43]
    v_pk_fma_f32 v[132:133], v[132:133], v[36:37], v[44:45]
    v_pk_fma_f32 v[134:135], v[134:135], v[38:39], v[46:47]
    v_cvt_pk_bf16_f32 v184, v128, v129
    v_cvt_pk_bf16_f32 v185, v130, v131
    v_cvt_pk_bf16_f32 v186, v132, v133
    v_cvt_pk_bf16_f32 v187, v134, v135
    buffer_store_dwordx4 v[184:187], v3, s[24:27], s69 offen offset:1792 sc0 sc1
    v_pk_fma_f32 v[136:137], v[136:137], s[34:35], s[34:35] op_sel:[0,0,1] op_sel_hi:[1,0,1]
    v_pk_fma_f32 v[138:139], v[138:139], s[34:35], s[34:35] op_sel:[0,0,1] op_sel_hi:[1,0,1]
    v_pk_fma_f32 v[140:141], v[140:141], s[34:35], s[34:35] op_sel:[0,0,1] op_sel_hi:[1,0,1]
    v_pk_fma_f32 v[142:143], v[142:143], s[34:35], s[34:35] op_sel:[0,0,1] op_sel_hi:[1,0,1]
    v_pk_fma_f32 v[136:137], v[136:137], v[32:33], v[40:41]
    v_pk_fma_f32 v[138:139], v[138:139], v[34:35], v[42:43]
    v_pk_fma_f32 v[140:141], v[140:141], v[36:37], v[44:45]
    v_pk_fma_f32 v[142:143], v[142:143], v[38:39], v[46:47]
    v_cvt_pk_bf16_f32 v188, v136, v137
    v_cvt_pk_bf16_f32 v189, v138, v139
    v_cvt_pk_bf16_f32 v190, v140, v141
    v_cvt_pk_bf16_f32 v191, v142, v143
    buffer_store_dwordx4 v[188:191], v3, s[24:27], s69 offen offset:2688 sc0 sc1
    s_mov_b32 s69, 1048576
    buffer_store_dwordx4 v[208:211], v3, s[24:27], s69 offen offset:0 sc0 sc1
    s_mov_b32 s69, 1048576
    buffer_store_dwordx4 v[212:215], v3, s[24:27], s69 offen offset:896 sc0 sc1
    s_mov_b32 s69, 1048576
    buffer_store_dwordx4 v[216:219], v3, s[24:27], s69 offen offset:1792 sc0 sc1
    s_mov_b32 s69, 1048576
    buffer_store_dwordx4 v[220:223], v3, s[24:27], s69 offen offset:2688 sc0 sc1
    s_add_u32 s66, s8, 49152
    s_nop 0
    s_waitcnt vmcnt(4)
    s_atomic_add s3, s[24:25], s66
    s_mov_b32 s69, 1507328
    buffer_store_dwordx4 v[224:227], v3, s[24:27], s69 offen offset:0 sc0 sc1
    s_mov_b32 s69, 1507328
    buffer_store_dwordx4 v[228:231], v3, s[24:27], s69 offen offset:896 sc0 sc1
    s_mov_b32 s69, 1507328
    buffer_store_dwordx4 v[232:235], v3, s[24:27], s69 offen offset:1792 sc0 sc1
    s_mov_b32 s69, 1507328
    buffer_store_dwordx4 v[236:239], v3, s[24:27], s69 offen offset:2688 sc0 sc1
    s_mov_b32 s69, 1966080
    buffer_store_dwordx4 v[80:83], v3, s[24:27], s69 offen offset:0 sc0 sc1
    s_mov_b32 s69, 1966080
    buffer_store_dwordx4 v[88:91], v3, s[24:27], s69 offen offset:896 sc0 sc1
    s_mov_b32 s69, 1966080
    buffer_store_dwordx4 v[96:99], v3, s[24:27], s69 offen offset:1792 sc0 sc1
    s_mov_b32 s69, 1966080
    buffer_store_dwordx4 v[104:107], v3, s[24:27], s69 offen offset:2688 sc0 sc1
    s_mov_b32 s69, 2424832
    buffer_store_dwordx4 v[144:147], v3, s[24:27], s69 offen offset:0 sc0 sc1
    s_mov_b32 s69, 2424832
    buffer_store_dwordx4 v[152:155], v3, s[24:27], s69 offen offset:896 sc0 sc1
    s_mov_b32 s69, 2424832
    buffer_store_dwordx4 v[160:163], v3, s[24:27], s69 offen offset:1792 sc0 sc1
    s_mov_b32 s69, 2424832
    buffer_store_dwordx4 v[168:171], v3, s[24:27], s69 offen offset:2688 sc0 sc1
    s_add_u32 s66, s8, 65536
    s_waitcnt vmcnt(0)
    s_atomic_add s3, s[24:25], s66
    s_cmp_eq_u32 s57, 0
    s_cselect_b32 s64, 0, 1073741824
    buffer_store_dword v2, v4, s[24:27], s64 offen sc0 sc1
    s_branch L_end
L_retry_3:
s_add_u32 s70, s70, 1
s_cmp_gt_u32 s70, 400000
s_cbranch_scc1 L_ok_2
s_mov_b32 s54, 0
s_atomic_add s54, s[24:25], s52 glc
s_waitcnt lgkmcnt(0)
s_sub_u32 s54, s54, s61
s_cmp_le_u32 s54, 16
s_cbranch_scc0 L_retry_3
s_branch L_ok_2
L_again_6:
s_add_u32 s70, s70, 1
s_cmp_gt_u32 s70, 400000
s_cbranch_scc1 L_ok_4
s_mov_b32 s54, 0
s_atomic_add s54, s[24:25], s53 glc
s_branch L_retry_5_0
L_retry_5:
s_waitcnt lgkmcnt(1)
s_cmp_eq_u32 s54, s47
s_cbranch_scc1 L_ok_4

L_retry_5_0:
s_waitcnt lgkmcnt(0)
s_cmp_eq_u32 s54, s47
s_cbranch_scc0 L_again_6
s_branch L_ok_4
L_again_9:
s_add_u32 s70, s70, 1
s_cmp_gt_u32 s70, 400000
s_cbranch_scc1 L_ok_7
s_mov_b32 s81, 0
s_atomic_add s81, s[24:25], s4 glc
s_branch L_retry_8_0
L_retry_8:
s_waitcnt lgkmcnt(1)
s_cmp_eq_u32 s81, s76
s_cbranch_scc1 L_ok_7

L_retry_8_0:
s_waitcnt lgkmcnt(0)
s_cmp_eq_u32 s81, s76
s_cbranch_scc0 L_again_9
s_branch L_ok_7
L_again_12:
s_add_u32 s70, s70, 1
s_cmp_gt_u32 s70, 400000
s_cbranch_scc1 L_ok_10
s_mov_b32 s78, 0
s_atomic_add s78, s[24:25], s12 glc
s_branch L_retry_11_0
L_retry_11:
s_waitcnt lgkmcnt(1)
s_cmp_eq_u32 s78, s76
s_cbranch_scc1 L_ok_10
s_waitcnt lgkmcnt(0)
s_cmp_eq_u32 s28, s76
s_cbranch_scc1 L_ok_10
L_retry_11_0:
s_waitcnt lgkmcnt(0)
s_cmp_eq_u32 s78, s76
s_cbranch_scc0 L_again_12
s_branch L_ok_10
L_again_15:
s_add_u32 s70, s70, 1
s_cmp_gt_u32 s70, 400000
s_cbranch_scc1 L_ok_13
s_mov_b32 s78, 0
s_atomic_add s78, s[24:25], s12 glc
s_branch L_retry_14_0
L_retry_14:
s_waitcnt lgkmcnt(1)
s_cmp_eq_u32 s78, s76
s_cbranch_scc1 L_ok_13
s_waitcnt lgkmcnt(0)
s_cmp_eq_u32 s29, s76
s_cbranch_scc1 L_ok_13
L_retry_14_0:
s_waitcnt lgkmcnt(0)
s_cmp_eq_u32 s78, s76
s_cbranch_scc0 L_again_15
s_branch L_ok_13
L_again_18:
s_add_u32 s70, s70, 1
s_cmp_gt_u32 s70, 400000
s_cbranch_scc1 L_ok_16
s_mov_b32 s78, 0
s_atomic_add s78, s[24:25], s12 glc
s_branch L_retry_17_0
L_retry_17:
s_waitcnt lgkmcnt(1)
s_cmp_eq_u32 s78, s76
s_cbranch_scc1 L_ok_16

L_retry_17_0:
s_waitcnt lgkmcnt(0)
s_cmp_eq_u32 s78, s76
s_cbranch_scc0 L_again_18
s_branch L_ok_16
L_again_21:
s_add_u32 s70, s70, 1
s_cmp_gt_u32 s70, 400000
s_cbranch_scc1 L_ok_19
s_mov_b32 s49, 0
s_atomic_add s49, s[24:25], s18 glc
s_branch L_retry_20_0
L_retry_20:
s_waitcnt lgkmcnt(1)
s_cmp_eq_u32 s49, s77
s_cbranch_scc1 L_ok_19

L_retry_20_0:
s_waitcnt lgkmcnt(0)
s_cmp_eq_u32 s49, s77
s_cbranch_scc0 L_again_21
s_branch L_ok_19
L_again_24:
s_add_u32 s70, s70, 1
s_cmp_gt_u32 s70, 400000
s_cbranch_scc1 L_ok_22
s_mov_b32 s49, 0
s_atomic_add s49, s[24:25], s18 glc
s_branch L_retry_23_0
L_retry_23:
s_waitcnt lgkmcnt(1)
s_cmp_eq_u32 s49, s77
s_cbranch_scc1 L_ok_22

L_retry_23_0:
s_waitcnt lgkmcnt(0)
s_cmp_eq_u32 s49, s77
s_cbranch_scc0 L_again_24
s_branch L_ok_22
L_again_27:
s_add_u32 s70, s70, 1
s_cmp_gt_u32 s70, 400000
s_cbranch_scc1 L_ok_25
s_mov_b32 s78, 0
s_atomic_add s78, s[24:25], s19 glc
s_branch L_retry_26_0
L_retry_26:
s_waitcnt lgkmcnt(1)
s_cmp_eq_u32 s78, s76
s_cbranch_scc1 L_ok_25

L_retry_26_0:
s_waitcnt lgkmcnt(0)
s_cmp_eq_u32 s78, s76
s_cbranch_scc0 L_again_27
s_branch L_ok_25
L_again_30:
s_add_u32 s70, s70, 1
s_cmp_gt_u32 s70, 400000
s_cbranch_scc1 L_ok_28
s_mov_b32 s49, 0
s_atomic_add s49, s[24:25], s18 glc
s_branch L_retry_29_0
L_retry_29:
s_waitcnt lgkmcnt(1)
s_cmp_eq_u32 s49, s77
s_cbranch_scc1 L_ok_28
s_waitcnt lgkmcnt(0)
s_cmp_eq_u32 s33, s77
s_cbranch_scc1 L_ok_28
L_retry_29_0:
s_waitcnt lgkmcnt(0)
s_cmp_eq_u32 s49, s77
s_cbranch_scc0 L_again_30
s_branch L_ok_28
L_again_33:
s_add_u32 s70, s70, 1
s_cmp_gt_u32 s70, 400000
s_cbranch_scc1 L_ok_31
s_mov_b32 s49, 0
s_atomic_add s49, s[24:25], s18 glc
s_branch L_retry_32_0
L_retry_32:
s_waitcnt lgkmcnt(1)
s_cmp_eq_u32 s49, s77
s_cbranch_scc1 L_ok_31
s_waitcnt lgkmcnt(0)
s_cmp_eq_u32 s34, s77
s_cbranch_scc1 L_ok_31
L_retry_32_0:
s_waitcnt lgkmcnt(0)
s_cmp_eq_u32 s49, s77
s_cbranch_scc0 L_again_33
s_branch L_ok_31
L_retry_37:
s_add_u32 s70, s70, 1
s_cmp_gt_u32 s70, 400000
s_cbranch_scc1 L_ok_36
s_mov_b32 s36, 0
s_atomic_add s36, s[24:25], 4096 glc
s_waitcnt lgkmcnt(0)
s_sub_u32 s36, s36, s61
s_cmp_le_u32 s36, 32
s_cbranch_scc0 L_retry_37
s_branch L_ok_36
L_retry_39:
s_add_u32 s70, s70, 1
s_cmp_gt_u32 s70, 400000
s_cbranch_scc1 L_ok_38
s_mov_b32 s37, 0
s_atomic_add s37, s[24:25], 4352 glc
s_waitcnt lgkmcnt(0)
s_sub_u32 s37, s37, s61
s_cmp_le_u32 s37, 32
s_cbranch_scc0 L_retry_39
s_branch L_ok_38
L_retry_42:
s_add_u32 s70, s70, 1
s_cmp_gt_u32 s70, 400000
s_cbranch_scc1 L_ok_41
s_mov_b32 s39, 0
s_atomic_add s39, s[24:25], s38 glc
s_waitcnt lgkmcnt(0)
s_cmp_eq_u32 s39, s36
s_cbranch_scc0 L_retry_42
s_branch L_ok_41
L_again_45:
s_add_u32 s70, s70, 1
s_cmp_gt_u32 s70, 400000
s_cbranch_scc1 L_ok_43
s_add_u32 s7, s12, 0
s_mov_b32 s20, 0
s_atomic_add s20, s[24:25], s7 glc
s_add_u32 s7, s13, 0
s_mov_b32 s21, 0
s_atomic_add s21, s[24:25], s7 glc
s_add_u32 s7, s14, 0
s_mov_b32 s22, 0
s_atomic_add s22, s[24:25], s7 glc
s_add_u32 s7, s15, 0
s_mov_b32 s23, 0
s_atomic_add s23, s[24:25], s7 glc
s_branch L_retry_44_0
L_retry_44:
s_waitcnt lgkmcnt(1)
s_xor_b64 s[72:73], s[20:21], s[76:77]
s_xor_b64 s[74:75], s[22:23], s[76:77]
s_or_b64 s[72:73], s[72:73], s[74:75]
s_cmp_eq_u64 s[72:73], 0
s_cbranch_scc1 L_ok_43

L_retry_44_0:
s_waitcnt lgkmcnt(0)
s_xor_b64 s[72:73], s[20:21], s[76:77]
s_xor_b64 s[74:75], s[22:23], s[76:77]
s_or_b64 s[72:73], s[72:73], s[74:75]
s_cmp_eq_u64 s[72:73], 0
s_cbranch_scc0 L_again_45
s_branch L_ok_43
L_again_48:
s_add_u32 s70, s70, 1
s_cmp_gt_u32 s70, 400000
s_cbranch_scc1 L_ok_46
s_add_u32 s7, s12, 16384
s_mov_b32 s20, 0
s_atomic_add s20, s[24:25], s7 glc
s_add_u32 s7, s13, 16384
s_mov_b32 s21, 0
s_atomic_add s21, s[24:25], s7 glc
s_add_u32 s7, s14, 16384
s_mov_b32 s22, 0
s_atomic_add s22, s[24:25], s7 glc
s_add_u32 s7, s15, 16384
s_mov_b32 s23, 0
s_atomic_add s23, s[24:25], s7 glc
s_branch L_retry_47_0
L_retry_47:
s_waitcnt lgkmcnt(1)
s_xor_b64 s[72:73], s[20:21], s[76:77]
s_xor_b64 s[74:75], s[22:23], s[76:77]
s_or_b64 s[72:73], s[72:73], s[74:75]
s_cmp_eq_u64 s[72:73], 0
s_cbranch_scc1 L_ok_46

L_retry_47_0:
s_waitcnt lgkmcnt(0)
s_xor_b64 s[72:73], s[20:21], s[76:77]
s_xor_b64 s[74:75], s[22:23], s[76:77]
s_or_b64 s[72:73], s[72:73], s[74:75]
s_cmp_eq_u64 s[72:73], 0
s_cbranch_scc0 L_again_48
s_branch L_ok_46
L_code_end:

.section .rodata,"a"
.p2align 6
.amdhsa_kernel adaLN_cond__ssm_conv_h3__glu_gated_bilinear__prompt_kernel
  .amdhsa_next_free_vgpr 512
  .amdhsa_next_free_sgpr 102
  .amdhsa_accum_offset 256
  .amdhsa_group_segment_fixed_size 0
  .amdhsa_kernarg_size 120
  .amdhsa_user_sgpr_count 2
  .amdhsa_user_sgpr_kernarg_segment_ptr 1
  .amdhsa_system_sgpr_workgroup_id_x 1
  .amdhsa_float_denorm_mode_32 3
.end_amdhsa_kernel
```
